```python
import torch

def _softmax(x, axis=-1):
    return torch.softmax(x, dim=axis)
def _gelu(x):
    return torch.nn.functional.gelu(x, approximate="tanh")
def _silu(x):
    return torch.nn.functional.silu(x)
def _sigmoid(x):
    return torch.sigmoid(x)
def _layernorm(x, axis=-1, eps=1e-5):
    m = x.mean(dim=axis, keepdim=True)
    v = x.var(dim=axis, keepdim=True, unbiased=False)
    return (x - m) / torch.sqrt(v + eps)
def _scatter_add(tgt, idx, src, axis=0):
    return tgt.clone().index_add_(axis, idx, src)
def _segment_sum(src, seg, n):
    out = torch.zeros((n,) + src.shape[1:], dtype=src.dtype)
    return out.index_add_(0, seg, src)
def _pad(x, pw):
    flat = tuple(v for pair in reversed(pw) for v in pair)
    return torch.nn.functional.pad(x, flat)

kernel_name = 'standalone__seq2seq_rnn_t_joint__speech'

def setup_inputs():

    _w = (lambda a: (lambda t: t.to(torch.bfloat16) if t.is_floating_point() else t)(torch.as_tensor(a)))
    B, T, D, K = 2, 1000, 256, 15
    U = 8
    sc = (1.0 / (K * D)) ** 0.5
    sd = (1.0 / D) ** 0.5
    return {
        "x": _w((lambda *s: torch.randn(*s, dtype=torch.bfloat16) * 0.2)(B, T, D) * 0.5),
        "w1": _w((lambda *s: torch.randn(*s, dtype=torch.bfloat16) * 3.2)(K, D, D) * sc),
        "w2": _w((lambda *s: torch.randn(*s, dtype=torch.bfloat16) * 3.2)(K, D, D) * sc),
        "g": _w((lambda *s: torch.randn(*s, dtype=torch.bfloat16) * 3.2)(B, U, D) * 0.5),
        "w_f": _w((lambda *s: torch.randn(*s, dtype=torch.bfloat16) * 3.2)(D, D) * sd),
        "w_g": _w((lambda *s: torch.randn(*s, dtype=torch.bfloat16) * 3.2)(D, D) * sd),
        "w_o": _w((lambda *s: torch.randn(*s, dtype=torch.bfloat16) * 3.2)(D, D) * sd),
    }

def reference(x, w1, w2, g, w_f, w_g, w_o):
    B, T, D = x.shape
    K = w1.shape[0]
    pad = K // 2
    xp = _pad(x, ((0,0),(pad,pad),(0,0)))
    h = torch.zeros_like(x)
    for i in range(K):
        h = h + torch.einsum("btc,cd->btd", xp[:, i:i+T, :], w1[i])
    h = _gelu(h)[:, ::2, :]
    T1 = h.shape[1]
    hp = _pad(h, ((0,0),(pad,pad),(0,0)))
    f = torch.zeros_like(h)
    for i in range(K):
        f = f + torch.einsum("btc,cd->btd", hp[:, i:i+T1, :], w2[i])
    f = _gelu(f)[:, ::2, :]
    fe = torch.einsum("btd,de->bte", f, w_f)
    ge = torch.einsum("bud,de->bue", g, w_g)
    j = torch.tanh(fe[:, :, None, :] + ge[:, None, :, :])
    return torch.einsum("btud,dv->btuv", j, w_o)
```

```asm
; @launch grid=(256,1,1) block=(512,1,1) lds=163840
.amdgcn_target "amdgcn-amd-amdhsa--gfx950"
.text
.globl standalone__seq2seq_rnn_t_joint__speech_kernel
.p2align 8
.type standalone__seq2seq_rnn_t_joint__speech_kernel,@function
standalone__seq2seq_rnn_t_joint__speech_kernel:
  s_load_dwordx2 s[4:5], s[0:1], 0
  s_load_dwordx2 s[8:9], s[0:1], 8
  s_load_dwordx2 s[24:25], s[0:1], 72
  s_load_dwordx16 s[64:79], s[0:1], 0
  s_cmp_ge_u32 s2, 256
  s_cbranch_scc1 L_end
  s_getpc_b64 s[80:81]
L_pc0:
  v_lshlrev_b32 v4, 7, v0
  v_min_u32 v4, L_code_end-L_pc0-4, v4
  global_load_dword v254, v4, s[80:81]
  v_lshrrev_b32 v6, 6, v0
  v_and_b32 v1, 63, v0
  v_readfirstlane_b32 s36, v6
  s_and_b32 s37, s2, 7
  s_lshr_b32 s38, s2, 3
  s_lshr_b32 s39, s37, 1
  s_bfe_u32 s40, s2, 0x30004
  s_lshr_b32 s41, s2, 7
  s_and_b32 s42, s2, 1
  s_bfe_u32 s43, s2, 0x10003
  s_lshl1_add_u32 s44, s42, s43
  s_mov_b32 s26, 10485760
  s_mov_b32 s27, 0x20000
  s_mov_b32 s10, 1966080
  s_mov_b32 s11, 0x20000
  v_mov_b32 v10, 0
  s_cmp_ge_u32 s36, 4
  s_cselect_b32 s45, 1, 0
  s_cmp_eq_u32 s45, 0
  s_cbranch_scc1 L_L
  s_setprio 2
  v_and_b32 v11, 1, v1
  v_bfe_u32 v12, v1, 1, 1
  v_lshlrev_b32 v11, 7, v11
  v_lshl_add_u32 v11, v12, 9, v11
  v_lshrrev_b32 v12, 2, v1
  v_lshl_add_u32 v11, v12, 17, v11
  s_lshl_b32 s46, s38, 10
  s_lshl_b32 s47, s39, 15
  s_add_u32 s46, s46, s47
  s_lshl_b32 s47, s42, 8
  s_add_u32 s46, s46, s47
  s_add_u32 s46, s46, 262144
  s_waitcnt lgkmcnt(0)
  s_cmp_lg_u32 s36, 4
  s_cbranch_scc1 L_nt
  buffer_load_dword v253, v11, s[8:11], s46 offen
L_nt:
  buffer_load_dword v243, v10, s[24:27], 0 offen sc1
  s_branch L_C
L_L:
  s_mov_b32 s6, 512000
  s_mov_b32 s7, 0x20000
  v_lshrrev_b32 v6, 4, v1
  v_xor_b32 v6, v6, v1
  v_and_b32 v6, 3, v6
  v_lshlrev_b32 v6, 4, v6
  v_lshrrev_b32 v8, 2, v1
  v_lshl_add_u32 v7, v8, 10, v6
  s_lshr_b32 s48, s36, 1
  s_and_b32 s49, s36, 1
  s_lshl2_add_u32 s46, s40, s48
  s_lshl_b32 s46, s46, 7
  s_add_u32 s46, s46, s39
  s_lshl1_add_u32 s46, s46, s49
  s_lshl_b32 s46, s46, 6
  s_sub_u32 s46, s46, 3584
  v_add_u32 v64, s46, v7
  v_add_u32 v65, 30720, v64
  v_add_u32 v66, 512, v64
  s_mul_i32 s50, s49, 6144
  s_lshl_b32 s48, s48, 10
  s_add_u32 s50, s50, s48
  s_add_u32 m0, s50, 131072
  v_and_b32 v6, 7, v1
  v_lshrrev_b32 v8, 3, v1
  v_and_b32 v9, 2, v8
  v_lshlrev_b32 v9, 1, v9
  v_xor_b32 v9, v9, v6
  v_lshlrev_b32 v9, 4, v9
  v_lshl_add_u32 v9, v8, 9, v9
  s_lshl2_add_u32 s48, s39, s36
  s_lshl_b32 s48, s48, 6
  s_add_u32 s48, s48, s44
  s_lshl_b32 s48, s48, 7
  v_add_u32 v206, s48, v9
  v_add_u32 v207, 3072, v206
  s_mul_i32 s51, s41, 512000
  s_lshl_b32 s52, s36, 11
  s_mov_b32 s48, 34816
  s_mov_b32 s49, 512
  s_mov_b32 s46, 35328
  s_waitcnt lgkmcnt(0)
  s_add_u32 s4, s4, s51
  s_addc_u32 s5, s5, 0
  buffer_load_dwordx4 v64, s[4:7], 0 offen lds
  buffer_load_dwordx4 v65, s[4:7], 0 offen offset:2048 lds
  s_cmp_ge_u32 s36, 2
  s_cbranch_scc1 L_x50
  s_add_u32 m0, m0, 4096
  s_nop 0
  buffer_load_dwordx4 v65, s[4:7], s48 offen lds
L_x50:
  s_add_u32 m0, s52, 0
  s_mov_b32 s53, 0
  buffer_load_dwordx4 v206, s[8:11], s53 offen lds
  buffer_load_dwordx4 v207, s[8:11], s53 offen offset:1024 lds
  buffer_load_dword v243, v10, s[24:27], 0 offen sc1
  s_add_u32 m0, s50, 143360
  s_nop 0
  buffer_load_dwordx4 v66, s[4:7], 0 offen lds
  buffer_load_dwordx4 v65, s[4:7], s49 offen offset:2048 lds
  s_cmp_ge_u32 s36, 2
  s_cbranch_scc1 L_x51
  s_add_u32 m0, m0, 4096
  s_nop 0
  buffer_load_dwordx4 v65, s[4:7], s46 offen lds
L_x51:
  s_add_u32 m0, s52, 8192
  s_mov_b32 s53, 131072
  buffer_load_dwordx4 v206, s[8:11], s53 offen lds
  buffer_load_dwordx4 v207, s[8:11], s53 offen offset:1024 lds
  s_add_u32 m0, s52, 16384
  s_mov_b32 s53, 262144
  buffer_load_dwordx4 v206, s[8:11], s53 offen lds
  buffer_load_dwordx4 v207, s[8:11], s53 offen offset:1024 lds
  s_add_u32 m0, s52, 24576
  s_mov_b32 s53, 393216
  buffer_load_dwordx4 v206, s[8:11], s53 offen lds
  buffer_load_dwordx4 v207, s[8:11], s53 offen offset:1024 lds
  s_waitcnt vmcnt(9)
  s_barrier
  s_add_u32 m0, s52, 32768
  s_mov_b32 s53, 524288
  buffer_load_dwordx4 v206, s[8:11], s53 offen lds
  buffer_load_dwordx4 v207, s[8:11], s53 offen offset:1024 lds
  s_add_u32 m0, s52, 40960
  s_mov_b32 s53, 655360
  buffer_load_dwordx4 v206, s[8:11], s53 offen lds
  buffer_load_dwordx4 v207, s[8:11], s53 offen offset:1024 lds
  s_add_u32 m0, s52, 49152
  s_mov_b32 s53, 786432
  buffer_load_dwordx4 v206, s[8:11], s53 offen lds
  buffer_load_dwordx4 v207, s[8:11], s53 offen offset:1024 lds
  s_waitcnt vmcnt(10)
  s_barrier
  s_add_u32 m0, s52, 57344
  s_mov_b32 s53, 917504
  buffer_load_dwordx4 v206, s[8:11], s53 offen lds
  buffer_load_dwordx4 v207, s[8:11], s53 offen offset:1024 lds
  s_add_u32 m0, s52, 65536
  s_mov_b32 s53, 1048576
  buffer_load_dwordx4 v206, s[8:11], s53 offen lds
  buffer_load_dwordx4 v207, s[8:11], s53 offen offset:1024 lds
  s_add_u32 m0, s52, 73728
  s_mov_b32 s53, 1179648
  buffer_load_dwordx4 v206, s[8:11], s53 offen lds
  buffer_load_dwordx4 v207, s[8:11], s53 offen offset:1024 lds
  s_add_u32 m0, s52, 81920
  s_mov_b32 s53, 1310720
  buffer_load_dwordx4 v206, s[8:11], s53 offen lds
  buffer_load_dwordx4 v207, s[8:11], s53 offen offset:1024 lds
  s_lshr_b32 s54, s38, 1
  s_lshl_b32 s55, s54, 17
  s_lshl_b32 s47, s37, 14
  s_add_u32 s55, s55, s47
  s_lshl_b32 s47, s43, 13
  s_add_u32 s55, s55, s47
  s_mov_b64 s[32:33], s[68:69]
  s_mov_b32 s34, 1966080
  s_mov_b32 s35, 0x20000
  s_lshl_b32 s54, s38, 12
  s_cmp_eq_u32 s36, 0
  s_cselect_b32 s55, s55, s54
  s_cselect_b32 s34, s34, 0x20000
  s_cmp_eq_u32 s36, 1
  s_cselect_b64 s[32:33], s[72:73], s[32:33]
  s_cmp_eq_u32 s36, 2
  s_cselect_b64 s[32:33], s[76:77], s[32:33]
  s_waitcnt vmcnt(14)
  s_barrier
  s_add_u32 m0, s52, 90112
  s_mov_b32 s53, 1441792
  buffer_load_dwordx4 v206, s[8:11], s53 offen lds
  buffer_load_dwordx4 v207, s[8:11], s53 offen offset:1024 lds
  s_add_u32 m0, s52, 98304
  s_mov_b32 s53, 1572864
  buffer_load_dwordx4 v206, s[8:11], s53 offen lds
  buffer_load_dwordx4 v207, s[8:11], s53 offen offset:1024 lds
  s_add_u32 m0, s52, 106496
  s_mov_b32 s53, 1703936
  buffer_load_dwordx4 v206, s[8:11], s53 offen lds
  buffer_load_dwordx4 v207, s[8:11], s53 offen offset:1024 lds
  s_and_b32 s56, s2, 3
  s_cmp_eq_u32 s36, 3
  s_cselect_b64 s[32:33], s[74:75], s[32:33]
  s_cselect_b32 s54, s56, 3
  s_cmp_lg_u32 s54, 3
  s_cselect_b32 s34, 0, s34
  v_lshlrev_b32 v252, 7, v1
  s_mov_b32 s57, 0
  s_mov_b32 s58, 0
  s_cmp_eq_u32 s2, 235
  s_cselect_b32 s57, 1, s57
  s_cselect_b32 s58, 0, s58
  s_cmp_eq_u32 s2, 243
  s_cselect_b32 s57, 1, s57
  s_cselect_b32 s58, 1, s58
  s_cmp_eq_u32 s2, 251
  s_cselect_b32 s57, 1, s57
  s_cselect_b32 s58, 2, s58
  s_cmp_eq_u32 s2, 239
  s_cselect_b32 s57, 1, s57
  s_cselect_b32 s58, 3, s58
  s_cmp_eq_u32 s2, 247
  s_cselect_b32 s57, 2, s57
  s_cmp_eq_u32 s2, 255
  s_cselect_b32 s57, 3, s57
  s_mov_b64 s[4:5], s[70:71]
  s_cmp_eq_u32 s57, 1
  s_cselect_b32 s6, 0x2000, 0
  v_lshrrev_b32 v7, 5, v1
  s_lshl_b32 s54, s36, 2
  v_add_u32 v7, s54, v7
  v_and_b32 v6, 31, v1
  v_xor_b32 v4, v6, v7
  v_lshlrev_b32 v4, 4, v4
  v_lshl_add_u32 v64, v7, 9, v4
  v_xor_b32 v65, 32, v64
  s_cmp_lg_u32 s57, 1
  s_cbranch_scc1 L_nog
  s_add_u32 m0, s52, 155648
  s_nop 0
  buffer_load_dwordx4 v64, s[4:7], 0 offen lds
  buffer_load_dwordx4 v65, s[4:7], 0 offen offset:1024 lds
L_nog:
  s_add_u32 m0, s52, 114688
  s_mov_b32 s53, 1835008
  buffer_load_dwordx4 v206, s[8:11], s53 offen lds
  buffer_load_dwordx4 v207, s[8:11], s53 offen offset:1024 lds
  s_cmp_eq_u32 s36, 0
  s_cselect_b32 exec_hi, -1, 0
  buffer_load_dword v253, v252, s[32:35], s55 offen
  s_mov_b64 exec, -1
  v_and_b32 v2, 15, v1
  v_lshrrev_b32 v3, 4, v1
  s_bfe_u32 s59, s2, 0x10004
  s_mov_b32 s60, 0x00010001
  s_mov_b32 s61, 0xfffefffe
  s_mov_b32 s62, 0x07060302
  s_mov_b64 s[12:13], s[68:69]
  s_mov_b32 s14, 1966080
  s_mov_b32 s15, 0x20000
  v_lshlrev_b32 v4, 2, v3
  v_xor_b32 v4, v4, v2
  v_lshlrev_b32 v4, 4, v4
  v_lshl_add_u32 v4, v3, 9, v4
  s_lshl_b32 s54, s37, 14
  s_lshl_b32 s47, s36, 12
  s_add_u32 s54, s54, s47
  s_waitcnt vmcnt(17)
  s_barrier
  s_lshl_b32 s47, s43, 8
  s_add_u32 s54, s54, s47
  s_lshl_b32 s47, s59, 17
  s_add_u32 s54, s54, s47
  v_add_u32 v208, s54, v4
  v_add_u32 v209, 1024, v208
  s_mov_b64 s[16:17], s[72:73]
  s_mov_b32 s18, 131072
  s_mov_b32 s19, 0x20000
  s_mov_b64 s[20:21], s[76:77]
  s_mov_b32 s22, 131072
  s_mov_b32 s23, 0x20000
  v_lshrrev_b32 v5, 5, v1
  v_and_b32 v6, 31, v1
  v_lshlrev_b32 v4, 1, v5
  v_xor_b32 v4, v4, v6
  s_waitcnt vmcnt(9)
  s_barrier
  v_lshlrev_b32 v4, 4, v4
  v_lshl_add_u32 v4, v5, 9, v4
  s_lshl_b32 s63, s36, 12
  v_add_u32 v210, s63, v4
  v_xor_b32 v211, 64, v210
  v_xor_b32 v212, 128, v210
  v_xor_b32 v213, 192, v210
  s_add_u32 m0, s52, 0
  s_mov_b32 s53, 0
  buffer_load_dwordx4 v208, s[12:15], s53 offen lds
  buffer_load_dwordx4 v209, s[12:15], s53 offen offset:1024 lds
  s_add_u32 m0, s52, 8192
  s_mov_b32 s53, 262144
  buffer_load_dwordx4 v208, s[12:15], s53 offen lds
  buffer_load_dwordx4 v209, s[12:15], s53 offen offset:1024 lds
  s_add_u32 m0, s52, 16384
  s_mov_b32 s53, 524288
  buffer_load_dwordx4 v208, s[12:15], s53 offen lds
  buffer_load_dwordx4 v209, s[12:15], s53 offen offset:1024 lds
  s_add_u32 m0, s52, 24576
  s_mov_b32 s53, 786432
  buffer_load_dwordx4 v208, s[12:15], s53 offen lds
  buffer_load_dwordx4 v209, s[12:15], s53 offen offset:1024 lds
  s_waitcnt vmcnt(9)
  s_barrier
  s_add_u32 m0, s52, 32768
  s_mov_b32 s53, 1048576
  buffer_load_dwordx4 v208, s[12:15], s53 offen lds
  buffer_load_dwordx4 v209, s[12:15], s53 offen offset:1024 lds
  s_add_u32 m0, s52, 40960
  s_mov_b32 s53, 1310720
  buffer_load_dwordx4 v208, s[12:15], s53 offen lds
  buffer_load_dwordx4 v209, s[12:15], s53 offen offset:1024 lds
  s_add_u32 m0, s52, 49152
  s_mov_b32 s53, 1572864
  buffer_load_dwordx4 v208, s[12:15], s53 offen lds
  buffer_load_dwordx4 v209, s[12:15], s53 offen offset:1024 lds
  s_add_u32 m0, s52, 57344
  s_mov_b32 s53, 1835008
  buffer_load_dwordx4 v208, s[12:15], s53 offen lds
  buffer_load_dwordx4 v209, s[12:15], s53 offen offset:1024 lds
  s_add_u32 m0, s63, 65536
  s_mov_b32 s53, 0
  buffer_load_dwordx4 v210, s[16:19], s53 offen offset:0 lds
  buffer_load_dwordx4 v211, s[16:19], s53 offen offset:1024 lds
  buffer_load_dwordx4 v212, s[16:19], s53 offen offset:2048 lds
  buffer_load_dwordx4 v213, s[16:19], s53 offen offset:3072 lds
  v_readfirstlane_b32 s84, v243
  s_nop 0
  s_add_u32 s84, s84, 1
  s_and_b32 s85, s84, 0xffff
  s_waitcnt vmcnt(4)
  s_barrier
  s_cmp_lg_u32 s57, 0
  s_cbranch_scc1 L_Lspecial
  s_add_u32 m0, s63, 81920
  s_mov_b32 s53, 16384
  buffer_load_dwordx4 v210, s[16:19], s53 offen offset:0 lds
  buffer_load_dwordx4 v211, s[16:19], s53 offen offset:1024 lds
  buffer_load_dwordx4 v212, s[16:19], s53 offen offset:2048 lds
  buffer_load_dwordx4 v213, s[16:19], s53 offen offset:3072 lds
  v_lshrrev_b32 v4, 2, v1
  v_and_b32 v9, 3, v1
  v_and_b32 v5, 7, v4
  v_lshlrev_b32 v6, 9, v4
  v_lshl_add_u32 v6, v9, 3, v6
  s_lshl_b32 s54, s36, 1
  v_xor_b32 v7, s54, v5
  v_lshl_add_u32 v215, v7, 5, v6
  v_xor_b32 v216, 32, v215
  v_add_u32 v217, 0x10000, v215
  v_add_u32 v218, 0x10000, v216
  s_waitcnt vmcnt(0)
  s_barrier
  ds_read_b64_tr_b16 v[128:129], v217 offset:0
  ds_read_b64_tr_b16 v[130:131], v217 offset:8192
  ds_read_b64_tr_b16 v[132:133], v218 offset:0
  ds_read_b64_tr_b16 v[134:135], v218 offset:8192
  ds_read_b64_tr_b16 v[136:137], v217 offset:16384
  ds_read_b64_tr_b16 v[138:139], v217 offset:24576
  ds_read_b64_tr_b16 v[140:141], v218 offset:16384
  ds_read_b64_tr_b16 v[142:143], v218 offset:24576
  s_waitcnt lgkmcnt(6)
  s_add_u32 m0, s63, 98304
  s_mov_b32 s53, 32768
  buffer_load_dwordx4 v210, s[16:19], s53 offen offset:0 lds
  buffer_load_dwordx4 v211, s[16:19], s53 offen offset:1024 lds
  buffer_load_dwordx4 v212, s[16:19], s53 offen offset:2048 lds
  buffer_load_dwordx4 v213, s[16:19], s53 offen offset:3072 lds
  s_waitcnt lgkmcnt(0)
  s_barrier
  s_add_u32 m0, s63, 114688
  s_mov_b32 s53, 49152
  buffer_load_dwordx4 v210, s[16:19], s53 offen offset:0 lds
  buffer_load_dwordx4 v211, s[16:19], s53 offen offset:1024 lds
  buffer_load_dwordx4 v212, s[16:19], s53 offen offset:2048 lds
  buffer_load_dwordx4 v213, s[16:19], s53 offen offset:3072 lds
  s_add_u32 m0, s63, 0
  s_mov_b32 s53, 65536
  buffer_load_dwordx4 v210, s[16:19], s53 offen offset:0 lds
  buffer_load_dwordx4 v211, s[16:19], s53 offen offset:1024 lds
  buffer_load_dwordx4 v212, s[16:19], s53 offen offset:2048 lds
  buffer_load_dwordx4 v213, s[16:19], s53 offen offset:3072 lds
  s_add_u32 m0, s63, 16384
  s_mov_b32 s53, 81920
  buffer_load_dwordx4 v210, s[16:19], s53 offen offset:0 lds
  buffer_load_dwordx4 v211, s[16:19], s53 offen offset:1024 lds
  buffer_load_dwordx4 v212, s[16:19], s53 offen offset:2048 lds
  buffer_load_dwordx4 v213, s[16:19], s53 offen offset:3072 lds
  s_add_u32 m0, s63, 32768
  s_mov_b32 s53, 98304
  buffer_load_dwordx4 v210, s[16:19], s53 offen offset:0 lds
  buffer_load_dwordx4 v211, s[16:19], s53 offen offset:1024 lds
  buffer_load_dwordx4 v212, s[16:19], s53 offen offset:2048 lds
  buffer_load_dwordx4 v213, s[16:19], s53 offen offset:3072 lds
  s_add_u32 m0, s63, 49152
  s_mov_b32 s53, 114688
  buffer_load_dwordx4 v210, s[16:19], s53 offen offset:0 lds
  buffer_load_dwordx4 v211, s[16:19], s53 offen offset:1024 lds
  buffer_load_dwordx4 v212, s[16:19], s53 offen offset:2048 lds
  buffer_load_dwordx4 v213, s[16:19], s53 offen offset:3072 lds
  s_mov_b64 s[28:29], s[78:79]
  s_mov_b32 s30, 2048000
  s_mov_b32 s31, 0x20000
  s_mov_b32 s86, 0xffff0000
  v_lshlrev_b32 v4, 4, v1
  v_add_u32 v240, 141312, v4
  s_lshl_b32 s54, s36, 10
  v_add_u32 v242, s54, v240
  v_lshrrev_b32 v4, 3, v2
  v_mul_u32_u24 v4, 576, v4
  v_lshl_add_u32 v4, v3, 4, v4
  v_add_u32 v238, 139264, v4
  s_lshr_b32 s87, s37, 2
  s_lshl_b32 s88, s87, 13
  s_lshl_b32 s47, s36, 10
  s_add_u32 s88, s88, s47
  s_add_u32 s88, s88, 8388608
  v_and_b32 v4, 7, v2
  v_lshlrev_b32 v4, 4, v4
  v_lshl_add_u32 v239, v3, 7, v4
  s_mul_i32 s89, s87, 250
  s_and_b32 s56, s37, 3
  s_lshl_b32 s47, s56, 6
  s_add_u32 s89, s89, s47
  s_lshl1_add_u32 s89, s38, s89
  s_lshl_b32 s89, s89, 12
  s_lshl_b32 s47, s36, 6
  s_add_u32 s89, s89, s47
  v_lshlrev_b32 v4, 9, v2
  v_and_b32 v5, 1, v3
  v_lshl_add_u32 v4, v5, 5, v4
  v_lshrrev_b32 v5, 1, v3
  v_lshl_add_u32 v241, v5, 4, v4
  s_mov_b64 s[20:21], s[76:77]
  s_mov_b32 s22, 131072
  s_mov_b32 s23, 0x20000
  v_lshrrev_b32 v5, 5, v1
  v_and_b32 v6, 31, v1
  v_lshlrev_b32 v4, 1, v5
  v_xor_b32 v4, v4, v6
  s_and_b32 s54, s36, 1
  s_lshl_b32 s54, s54, 3
  v_xor_b32 v4, s54, v4
  s_lshl_b32 s52, s36, 11
  v_lshl_add_u32 v4, v4, 4, s52
  v_lshl_add_u32 v233, v5, 9, v4
  v_xor_b32 v234, 64, v233
  s_waitcnt vmcnt(0)
  s_barrier
  ds_read_b64_tr_b16 v[144:145], v217 offset:32768
  ds_read_b64_tr_b16 v[146:147], v217 offset:40960
  ds_read_b64_tr_b16 v[148:149], v218 offset:32768
  ds_read_b64_tr_b16 v[150:151], v218 offset:40960
  ds_read_b64_tr_b16 v[152:153], v217 offset:49152
  ds_read_b64_tr_b16 v[154:155], v217 offset:57344
  ds_read_b64_tr_b16 v[156:157], v218 offset:49152
  ds_read_b64_tr_b16 v[158:159], v218 offset:57344
  s_waitcnt lgkmcnt(6)
  ds_read_b64_tr_b16 v[160:161], v215 offset:0
  ds_read_b64_tr_b16 v[162:163], v215 offset:8192
  ds_read_b64_tr_b16 v[164:165], v216 offset:0
  ds_read_b64_tr_b16 v[166:167], v216 offset:8192
  ds_read_b64_tr_b16 v[168:169], v215 offset:16384
  ds_read_b64_tr_b16 v[170:171], v215 offset:24576
  ds_read_b64_tr_b16 v[172:173], v216 offset:16384
  ds_read_b64_tr_b16 v[174:175], v216 offset:24576
  s_waitcnt lgkmcnt(6)
  ds_read_b64_tr_b16 v[176:177], v215 offset:32768
  ds_read_b64_tr_b16 v[178:179], v215 offset:40960
  ds_read_b64_tr_b16 v[180:181], v216 offset:32768
  ds_read_b64_tr_b16 v[182:183], v216 offset:40960
  ds_read_b64_tr_b16 v[184:185], v215 offset:49152
  ds_read_b64_tr_b16 v[186:187], v215 offset:57344
  ds_read_b64_tr_b16 v[188:189], v216 offset:49152
  ds_read_b64_tr_b16 v[190:191], v216 offset:57344
  s_waitcnt lgkmcnt(6)
  s_waitcnt lgkmcnt(0)
  s_barrier
  s_add_u32 m0, s63, 65536
  s_mov_b32 s53, 65536
  buffer_load_dwordx4 v210, s[20:23], s53 offen offset:0 lds
  buffer_load_dwordx4 v211, s[20:23], s53 offen offset:1024 lds
  buffer_load_dwordx4 v212, s[20:23], s53 offen offset:2048 lds
  buffer_load_dwordx4 v213, s[20:23], s53 offen offset:3072 lds
  s_add_u32 m0, s63, 81920
  s_mov_b32 s53, 81920
  buffer_load_dwordx4 v210, s[20:23], s53 offen offset:0 lds
  buffer_load_dwordx4 v211, s[20:23], s53 offen offset:1024 lds
  buffer_load_dwordx4 v212, s[20:23], s53 offen offset:2048 lds
  buffer_load_dwordx4 v213, s[20:23], s53 offen offset:3072 lds
  s_add_u32 m0, s63, 98304
  s_mov_b32 s53, 98304
  buffer_load_dwordx4 v210, s[20:23], s53 offen offset:0 lds
  buffer_load_dwordx4 v211, s[20:23], s53 offen offset:1024 lds
  buffer_load_dwordx4 v212, s[20:23], s53 offen offset:2048 lds
  buffer_load_dwordx4 v213, s[20:23], s53 offen offset:3072 lds
  s_add_u32 m0, s63, 114688
  s_mov_b32 s53, 114688
  buffer_load_dwordx4 v210, s[20:23], s53 offen offset:0 lds
  buffer_load_dwordx4 v211, s[20:23], s53 offen offset:1024 lds
  buffer_load_dwordx4 v212, s[20:23], s53 offen offset:2048 lds
  buffer_load_dwordx4 v213, s[20:23], s53 offen offset:3072 lds
  s_add_u32 m0, s63, 49152
  s_mov_b32 s53, 49152
  buffer_load_dwordx4 v210, s[20:23], s53 offen offset:0 lds
  buffer_load_dwordx4 v211, s[20:23], s53 offen offset:1024 lds
  buffer_load_dwordx4 v212, s[20:23], s53 offen offset:2048 lds
  buffer_load_dwordx4 v213, s[20:23], s53 offen offset:3072 lds
  s_waitcnt vmcnt(0)
  s_barrier
  ds_read_b64_tr_b16 v[96:97], v217 offset:0
  ds_read_b64_tr_b16 v[98:99], v217 offset:8192
  ds_read_b64_tr_b16 v[100:101], v218 offset:0
  ds_read_b64_tr_b16 v[102:103], v218 offset:8192
  ds_read_b64_tr_b16 v[104:105], v217 offset:16384
  ds_read_b64_tr_b16 v[106:107], v217 offset:24576
  ds_read_b64_tr_b16 v[108:109], v218 offset:16384
  ds_read_b64_tr_b16 v[110:111], v218 offset:24576
  s_waitcnt lgkmcnt(6)
  ds_read_b64_tr_b16 v[112:113], v217 offset:32768
  ds_read_b64_tr_b16 v[114:115], v217 offset:40960
  ds_read_b64_tr_b16 v[116:117], v218 offset:32768
  ds_read_b64_tr_b16 v[118:119], v218 offset:40960
  ds_read_b64_tr_b16 v[120:121], v217 offset:49152
  ds_read_b64_tr_b16 v[122:123], v217 offset:57344
  ds_read_b64_tr_b16 v[124:125], v218 offset:49152
  ds_read_b64_tr_b16 v[126:127], v218 offset:57344
  s_waitcnt lgkmcnt(6)
  s_mov_b32 s90, 0
L_g3L:
  buffer_load_dwordx4 v[16:19], v239, s[24:27], s88 offen sc1
  buffer_load_dwordx4 v[20:23], v239, s[24:27], s88 offen offset:512 sc1
  s_add_u32 s90, s90, 1
  s_waitcnt vmcnt(0)
  v_xor_b32 v4, s85, v16
  v_bitop3_b32 v4, v4, v17, s85 bitop3:0xf6
  v_bitop3_b32 v4, v4, v18, s85 bitop3:0xf6
  v_bitop3_b32 v4, v4, v19, s85 bitop3:0xf6
  v_bitop3_b32 v4, v4, v20, s85 bitop3:0xf6
  v_bitop3_b32 v4, v4, v21, s85 bitop3:0xf6
  v_bitop3_b32 v4, v4, v22, s85 bitop3:0xf6
  v_bitop3_b32 v4, v4, v23, s85 bitop3:0xf6
  v_and_b32 v4, 0xffff, v4
  v_cmp_ne_u32 vcc, 0, v4
  s_cmp_gt_u32 s90, 20000
  s_cbranch_scc1 L_g3okL
  s_cmp_lg_u64 vcc, 0
  s_cbranch_scc1 L_g3L
L_g3okL:
  v_and_b32 v16, s86, v16
  v_and_b32 v17, s86, v17
  v_and_b32 v18, s86, v18
  v_and_b32 v19, s86, v19
  v_and_b32 v20, s86, v20
  v_and_b32 v21, s86, v21
  v_and_b32 v22, s86, v22
  v_and_b32 v23, s86, v23
  s_branch L_join2
L_C:
  s_and_b32 s12, s36, 1
  s_bfe_u32 s13, s36, 0x10001
  v_and_b32 v248, 31, v1
  v_lshrrev_b32 v249, 5, v1
  v_and_b32 v8, 15, v1
  v_bfe_u32 v9, v1, 4, 1
  v_lshl_add_u32 v8, v8, 1, v9
  s_lshl_b32 s48, s12, 5
  v_add_u32 v190, s48, v8
  s_mov_b32 s48, 131072
  v_lshl_add_u32 v191, v190, 6, s48
  v_bfe_u32 v12, v190, 2, 2
  v_xor_b32 v12, v12, v249
  v_lshl_add_u32 v168, v12, 4, v191
  v_xor_b32 v169, 32, v168
  v_add_u32 v12, 1, v190
  v_bfe_u32 v12, v12, 2, 2
  v_xor_b32 v12, v12, v249
  v_lshl_add_u32 v170, v12, 4, v191
  v_xor_b32 v171, 32, v170
  v_bfe_u32 v8, v1, 2, 2
  v_and_b32 v5, 3, v1
  v_lshrrev_b32 v4, 5, v1
  v_lshl_add_u32 v4, v4, 3, v8
  v_lshlrev_b32 v4, 7, v4
  v_lshl_add_u32 v4, v5, 3, v4
  v_bfe_u32 v5, v1, 4, 1
  v_lshl_add_u32 v4, v5, 5, v4
  v_lshrrev_b32 v5, 1, v8
  v_xor_b32 v5, s13, v5
  v_lshl_add_u32 v244, v5, 6, v4
  v_add_u32 v245, 0x10000, v244
  v_add_u32 v12, 2, v190
  v_bfe_u32 v12, v12, 2, 2
  v_xor_b32 v12, v12, v249
  v_lshl_add_u32 v172, v12, 4, v191
  v_xor_b32 v173, 32, v172
  v_add_u32 v12, 3, v190
  v_bfe_u32 v12, v12, 2, 2
  v_xor_b32 v12, v12, v249
  v_lshl_add_u32 v174, v12, 4, v191
  v_xor_b32 v175, 32, v174
  v_add_u32 v12, 4, v190
  v_bfe_u32 v12, v12, 2, 2
  v_xor_b32 v12, v12, v249
  v_lshl_add_u32 v176, v12, 4, v191
  v_xor_b32 v177, 32, v176
  v_add_u32 v12, 5, v190
  v_bfe_u32 v12, v12, 2, 2
  v_xor_b32 v12, v12, v249
  v_lshl_add_u32 v178, v12, 4, v191
  v_xor_b32 v179, 32, v178
  v_add_u32 v12, 6, v190
  v_bfe_u32 v12, v12, 2, 2
  v_xor_b32 v12, v12, v249
  v_lshl_add_u32 v180, v12, 4, v191
  v_xor_b32 v181, 32, v180
  v_add_u32 v12, 7, v190
  v_bfe_u32 v12, v12, 2, 2
  v_xor_b32 v12, v12, v249
  v_lshl_add_u32 v182, v12, 4, v191
  v_xor_b32 v183, 32, v182
  v_and_b32 v2, 15, v1
  v_lshrrev_b32 v3, 4, v1
  s_bfe_u32 s59, s2, 0x10004
  s_mov_b32 s60, 0x00010001
  s_mov_b32 s61, 0xfffefffe
  s_mov_b32 s62, 0x07060302
  s_and_b32 s14, s36, 3
  s_lshl_b32 s15, s41, 20
  s_lshl_b32 s47, s44, 18
  s_add_u32 s15, s15, s47
  s_lshl_b32 s47, s13, 17
  s_add_u32 s15, s15, s47
  s_lshl_b32 s47, s39, 15
  s_add_u32 s15, s15, s47
  s_lshl_b32 s47, s40, 9
  s_add_u32 s15, s15, s47
  s_lshl_b32 s47, s12, 8
  s_add_u32 s15, s15, s47
  s_add_u32 s15, s15, 1048640
  s_add_u32 s16, s15, 8192
  v_bfe_u32 v5, v1, 4, 1
  v_lshlrev_b32 v5, 14, v5
  v_lshl_add_u32 v5, v249, 12, v5
  v_lshl_add_u32 v184, v2, 4, v5
  v_add_u32 v14, 4, v2
  v_and_b32 v14, 15, v14
  v_bfe_u32 v8, v1, 2, 2
  v_and_b32 v9, 3, v1
  v_lshl_add_u32 v4, v249, 2, v8
  v_lshlrev_b32 v4, 8, v4
  v_lshl_add_u32 v4, v9, 3, v4
  v_bfe_u32 v5, v1, 4, 1
  v_lshl_add_u32 v4, v5, 5, v4
  v_xor_b32 v5, s14, v8
  v_lshl_add_u32 v214, v5, 6, v4
  v_add_u32 v4, s59, v248
  v_mul_u32_u24 v4, 80, v4
  v_lshl_add_u32 v4, v249, 4, v4
  v_add_u32 v231, 131072, v4
  s_lshr_b32 s17, s2, 5
  s_lshl_b32 s18, s17, 19
  s_lshl_b32 s47, s59, 13
  s_add_u32 s18, s18, s47
  s_lshl_b32 s47, s37, 10
  s_add_u32 s18, s18, s47
  s_lshl_b32 s47, s43, 9
  s_add_u32 s18, s18, s47
  s_lshl_b32 s47, s14, 7
  s_add_u32 s18, s18, s47
  s_add_u32 s18, s18, 4194304
  v_lshrrev_b32 v4, 2, v248
  v_lshlrev_b32 v4, 15, v4
  v_and_b32 v5, 3, v1
  v_lshl_add_u32 v15, v249, 2, v5
  v_lshl_add_u32 v223, v15, 4, v4
  v_add_u32 v224, 0x4000, v223
  s_add_u32 s19, s18, 262144
  s_lshl_b32 s54, s12, 3
  v_add_u32 v15, s54, v15
  s_mov_b32 s57, 0
  s_mov_b32 s58, 0
  s_cmp_eq_u32 s2, 235
  s_cselect_b32 s57, 1, s57
  s_cselect_b32 s58, 0, s58
  s_cmp_eq_u32 s2, 243
  s_cselect_b32 s57, 1, s57
  s_cselect_b32 s58, 1, s58
  s_cmp_eq_u32 s2, 251
  s_cselect_b32 s57, 1, s57
  s_cselect_b32 s58, 2, s58
  s_cmp_eq_u32 s2, 239
  s_cselect_b32 s57, 1, s57
  s_cselect_b32 s58, 3, s58
  s_cmp_eq_u32 s2, 247
  s_cselect_b32 s57, 2, s57
  s_cmp_eq_u32 s2, 255
  s_cselect_b32 s57, 3, s57
  v_lshrrev_b32 v4, 2, v1
  v_and_b32 v9, 3, v1
  v_and_b32 v5, 7, v4
  v_lshlrev_b32 v6, 9, v4
  v_lshl_add_u32 v6, v9, 3, v6
  s_lshl_b32 s54, s36, 1
  v_xor_b32 v7, s54, v5
  v_lshl_add_u32 v215, v7, 5, v6
  v_xor_b32 v216, 32, v215
  v_add_u32 v217, 0x10000, v215
  v_add_u32 v218, 0x10000, v216
  s_bfe_u32 s4, s2, 0x20005
  s_mov_b32 s82, 0xbdd2d3e8
  s_mov_b32 s83, 0xbdd2d3e8
  v_mov_b32 v246, 0xc0135761
  v_mov_b32 v247, 0xc0135761
  v_and_b32 v8, 1, v2
  v_lshlrev_b32 v4, 4, v8
  v_mov_b32 v5, 0x3f80
  v_lshlrev_b32 v4, v4, v5
  v_lshrrev_b32 v5, 1, v2
  v_cmp_eq_u32 vcc, 0, v5
  s_nop 1
  v_cndmask_b32 v192, 0, v4, vcc
  v_cmp_eq_u32 vcc, 1, v5
  s_nop 1
  v_cndmask_b32 v193, 0, v4, vcc
  v_cmp_eq_u32 vcc, 2, v5
  s_nop 1
  v_cndmask_b32 v194, 0, v4, vcc
  v_cmp_eq_u32 vcc, 3, v5
  s_nop 1
  v_cndmask_b32 v195, 0, v4, vcc
  v_cmp_eq_u32 vcc, 4, v5
  s_nop 1
  v_cndmask_b32 v196, 0, v4, vcc
  v_cmp_eq_u32 vcc, 5, v5
  s_nop 1
  v_cndmask_b32 v197, 0, v4, vcc
  v_cmp_eq_u32 vcc, 6, v5
  s_nop 1
  v_cndmask_b32 v198, 0, v4, vcc
  v_cmp_eq_u32 vcc, 7, v5
  s_nop 1
  v_cndmask_b32 v199, 0, v4, vcc
  s_xor_b32 s54, s59, 1
  s_lshl_b32 s5, s41, 20
  s_lshl_b32 s47, s37, 17
  s_add_u32 s5, s5, s47
  s_lshl_b32 s47, s54, 14
  s_add_u32 s5, s5, s47
  s_lshl_b32 s47, s4, 10
  s_add_u32 s5, s5, s47
  s_add_u32 s5, s5, 1048576
  v_lshlrev_b32 v4, 15, v3
  v_lshl_add_u32 v4, v2, 4, v4
  s_lshl_b32 s54, s4, 6
  s_lshl4_add_u32 s54, s14, s54
  s_sub_u32 s54, s54, 4
  v_add_u32 v6, s54, v2
  v_cmp_gt_u32 vcc, 250, v6
  s_lshl_b32 s54, s14, 8
  v_add_u32 v6, s54, v4
  v_mov_b32 v7, 0x7ff00000
  v_mov_b32 v11, 0x10001
  v_cndmask_b32 v225, v7, v6, vcc
  v_cndmask_b32 v227, 0, v11, vcc
  s_lshl_b32 s54, s14, 12
  s_add_u32 s54, s54, 1024
  v_add_u32 v6, s54, v4
  s_cmp_lt_u32 s4, 3
  s_cselect_b32 s54, 8, 0
  v_cmp_gt_u32 vcc, s54, v2
  s_nop 1
  v_cndmask_b32 v226, v7, v6, vcc
  v_cndmask_b32 v228, 0, v11, vcc
  v_mul_u32_u24 v4, 80, v2
  v_lshl_add_u32 v4, v3, 3, v4
  s_lshl_b32 s54, s14, 4
  s_add_u32 s54, s54, 136192
  v_add_u32 v230, s54, v4
  s_mul_i32 s54, s14, 1280
  s_add_u32 s54, s54, 131072
  v_add_u32 v229, s54, v4
  s_add_u32 s6, s5, 4096
  s_add_u32 s7, s5, 8192
  s_add_u32 s8, s5, 12288
  s_lshl_b32 s9, s41, 16
  s_lshl_b32 s47, s44, 14
  s_add_u32 s9, s9, s47
  s_lshl_b32 s47, s13, 13
  s_add_u32 s9, s9, s47
  s_lshl_b32 s47, s40, 10
  s_add_u32 s9, s9, s47
  s_lshl_b32 s47, s12, 9
  s_add_u32 s9, s9, s47
  s_lshl_b32 s47, s39, 7
  s_add_u32 s9, s9, s47
  s_add_u32 s9, s9, 131072
  s_lshl_b32 s54, s4, 2
  s_sub_u32 s54, s54, 1
  v_lshrrev_b32 v4, 2, v1
  v_add_u32 v4, s54, v4
  v_cmp_gt_u32 vcc, 16, v4
  v_cmp_gt_u32 s[80:81], 24, v1
  s_nop 0
  s_and_b64 vcc, vcc, s[80:81]
  s_lshl_b32 s54, s54, 9
  v_lshl_add_u32 v4, v1, 7, s54
  v_mov_b32 v7, 0x7ff00000
  v_cndmask_b32 v250, v7, v4, vcc
  v_cndmask_b32 v251, 0, -1, vcc
  s_lshl_b32 s10, s41, 16
  s_lshl_b32 s47, s37, 13
  s_add_u32 s10, s10, s47
  s_add_u32 s10, s10, 131072
  s_lshl_b32 s11, s17, 14
  s_lshl_b32 s47, s43, 13
  s_add_u32 s11, s11, s47
  s_lshl_b32 s47, s13, 12
  s_add_u32 s11, s11, s47
  s_lshl_b32 s47, s59, 11
  s_add_u32 s11, s11, s47
  s_lshl_b32 s47, s37, 8
  s_add_u32 s11, s11, s47
  s_lshl_b32 s47, s12, 7
  s_add_u32 s11, s11, s47
  s_add_u32 s11, s11, 262144
  v_lshlrev_b32 v252, 7, v248
  s_lshl_b32 s32, s37, 14
  s_lshl_b32 s47, s14, 12
  s_add_u32 s32, s32, s47
  s_add_u32 s32, s32, 262144
  s_barrier
  ds_read_b64_tr_b16 v[128:129], v244 offset:0
  ds_read_b64_tr_b16 v[130:131], v244 offset:512
  ds_read_b128 v[132:135], v168 offset:0
  ds_read_b64_tr_b16 v[136:137], v244 offset:2048
  ds_read_b64_tr_b16 v[138:139], v244 offset:2560
  ds_read_b128 v[140:143], v169 offset:0
  ds_read_b64_tr_b16 v[144:145], v244 offset:4096
  ds_read_b64_tr_b16 v[146:147], v244 offset:4608
  ds_read_b128 v[148:151], v168 offset:6144
  ds_read_b64_tr_b16 v[152:153], v244 offset:6144
  ds_read_b64_tr_b16 v[154:155], v244 offset:6656
  ds_read_b128 v[156:159], v169 offset:6144
  s_waitcnt lgkmcnt(9)
  v_mfma_f32_32x32x16_bf16 v[16:31], v[128:131], v[132:135], 0
  s_barrier
  ds_read_b64_tr_b16 v[160:161], v244 offset:8192
  ds_read_b64_tr_b16 v[162:163], v244 offset:8704
  ds_read_b128 v[164:167], v168 offset:12288
  s_waitcnt lgkmcnt(9)
  v_mfma_f32_32x32x16_bf16 v[16:31], v[136:139], v[140:143], v[16:31]
  ds_read_b64_tr_b16 v[128:129], v244 offset:10240
  ds_read_b64_tr_b16 v[130:131], v244 offset:10752
  ds_read_b128 v[132:135], v169 offset:12288
  s_waitcnt lgkmcnt(9)
  v_mfma_f32_32x32x16_bf16 v[16:31], v[144:147], v[148:151], v[16:31]
  ds_read_b64_tr_b16 v[136:137], v244 offset:12288
  ds_read_b64_tr_b16 v[138:139], v244 offset:12800
  ds_read_b128 v[140:143], v168 offset:18432
  s_waitcnt vmcnt(0)
  s_waitcnt lgkmcnt(9)
  v_mfma_f32_32x32x16_bf16 v[16:31], v[152:155], v[156:159], v[16:31]
  ds_read_b64_tr_b16 v[144:145], v244 offset:14336
  ds_read_b64_tr_b16 v[146:147], v244 offset:14848
  ds_read_b128 v[148:151], v169 offset:18432
  v_readfirstlane_b32 s84, v243
  s_waitcnt lgkmcnt(9)
  v_mfma_f32_32x32x16_bf16 v[16:31], v[160:163], v[164:167], v[16:31]
  s_barrier
  ds_read_b64_tr_b16 v[152:153], v244 offset:16384
  ds_read_b64_tr_b16 v[154:155], v244 offset:16896
  ds_read_b128 v[156:159], v170 offset:64
  s_add_u32 s84, s84, 1
  s_waitcnt lgkmcnt(9)
  v_mfma_f32_32x32x16_bf16 v[16:31], v[128:131], v[132:135], v[16:31]
  ds_read_b64_tr_b16 v[160:161], v244 offset:18432
  ds_read_b64_tr_b16 v[162:163], v244 offset:18944
  ds_read_b128 v[164:167], v171 offset:64
  s_and_b32 s85, s84, 0xffff
  s_waitcnt lgkmcnt(9)
  v_mfma_f32_32x32x16_bf16 v[16:31], v[136:139], v[140:143], v[16:31]
  ds_read_b64_tr_b16 v[128:129], v244 offset:20480
  ds_read_b64_tr_b16 v[130:131], v244 offset:20992
  ds_read_b128 v[132:135], v170 offset:6208
  v_mad_u32_u24 v4, v14, 37, s84
  s_waitcnt lgkmcnt(9)
  v_mfma_f32_32x32x16_bf16 v[16:31], v[144:147], v[148:151], v[16:31]
  ds_read_b64_tr_b16 v[136:137], v244 offset:22528
  ds_read_b64_tr_b16 v[138:139], v244 offset:23040
  ds_read_b128 v[140:143], v171 offset:6208
  v_and_b32 v4, 0xff, v4
  s_waitcnt lgkmcnt(9)
  v_mfma_f32_32x32x16_bf16 v[16:31], v[152:155], v[156:159], v[16:31]
  ds_read_b64_tr_b16 v[144:145], v244 offset:24576
  ds_read_b64_tr_b16 v[146:147], v244 offset:25088
  ds_read_b128 v[148:151], v170 offset:12352
  v_lshl_or_b32 v4, v4, 15, v4
  s_waitcnt lgkmcnt(9)
  v_mfma_f32_32x32x16_bf16 v[16:31], v[160:163], v[164:167], v[16:31]
  ds_read_b64_tr_b16 v[152:153], v244 offset:26624
  ds_read_b64_tr_b16 v[154:155], v244 offset:27136
  ds_read_b128 v[156:159], v171 offset:12352
  v_and_b32 v186, s60, v4
  s_waitcnt lgkmcnt(9)
  v_mfma_f32_32x32x16_bf16 v[16:31], v[128:131], v[132:135], v[16:31]
  ds_read_b64_tr_b16 v[160:161], v244 offset:28672
  ds_read_b64_tr_b16 v[162:163], v244 offset:29184
  ds_read_b128 v[164:167], v170 offset:18496
  v_lshrrev_b32 v4, 2, v4
  s_waitcnt lgkmcnt(9)
  v_mfma_f32_32x32x16_bf16 v[16:31], v[136:139], v[140:143], v[16:31]
  ds_read_b64_tr_b16 v[128:129], v244 offset:30720
  ds_read_b64_tr_b16 v[130:131], v244 offset:31232
  ds_read_b128 v[132:135], v171 offset:18496
  v_and_b32 v187, s60, v4
  s_waitcnt lgkmcnt(9)
  v_mfma_f32_32x32x16_bf16 v[16:31], v[144:147], v[148:151], v[16:31]
  s_barrier
  ds_read_b64_tr_b16 v[136:137], v244 offset:32768
  ds_read_b64_tr_b16 v[138:139], v244 offset:33280
  ds_read_b128 v[140:143], v172 offset:128
  v_lshrrev_b32 v4, 2, v4
  s_waitcnt lgkmcnt(9)
  v_mfma_f32_32x32x16_bf16 v[16:31], v[152:155], v[156:159], v[16:31]
  ds_read_b64_tr_b16 v[144:145], v244 offset:34816
  ds_read_b64_tr_b16 v[146:147], v244 offset:35328
  ds_read_b128 v[148:151], v173 offset:128
  v_and_b32 v188, s60, v4
  s_waitcnt lgkmcnt(9)
  v_mfma_f32_32x32x16_bf16 v[16:31], v[160:163], v[164:167], v[16:31]
  ds_read_b64_tr_b16 v[152:153], v244 offset:36864
  ds_read_b64_tr_b16 v[154:155], v244 offset:37376
  ds_read_b128 v[156:159], v172 offset:6272
  v_lshrrev_b32 v4, 2, v4
  s_waitcnt lgkmcnt(9)
  v_mfma_f32_32x32x16_bf16 v[16:31], v[128:131], v[132:135], v[16:31]
  ds_read_b64_tr_b16 v[160:161], v244 offset:38912
  ds_read_b64_tr_b16 v[162:163], v244 offset:39424
  ds_read_b128 v[164:167], v173 offset:6272
  v_and_b32 v189, s60, v4
  s_waitcnt lgkmcnt(9)
  v_mfma_f32_32x32x16_bf16 v[16:31], v[136:139], v[140:143], v[16:31]
  ds_read_b64_tr_b16 v[128:129], v244 offset:40960
  ds_read_b64_tr_b16 v[130:131], v244 offset:41472
  ds_read_b128 v[132:135], v172 offset:12416
  v_mad_u32_u24 v4, v15, 37, s84
  s_waitcnt lgkmcnt(9)
  v_mfma_f32_32x32x16_bf16 v[16:31], v[144:147], v[148:151], v[16:31]
  ds_read_b64_tr_b16 v[136:137], v244 offset:43008
  ds_read_b64_tr_b16 v[138:139], v244 offset:43520
  ds_read_b128 v[140:143], v173 offset:12416
  v_and_b32 v4, 0xff, v4
  s_waitcnt lgkmcnt(9)
  v_mfma_f32_32x32x16_bf16 v[16:31], v[152:155], v[156:159], v[16:31]
  ds_read_b64_tr_b16 v[144:145], v244 offset:45056
  ds_read_b64_tr_b16 v[146:147], v244 offset:45568
  ds_read_b128 v[148:151], v172 offset:18560
  v_lshl_or_b32 v4, v4, 15, v4
  s_waitcnt lgkmcnt(9)
  v_mfma_f32_32x32x16_bf16 v[16:31], v[160:163], v[164:167], v[16:31]
  ds_read_b64_tr_b16 v[152:153], v244 offset:47104
  ds_read_b64_tr_b16 v[154:155], v244 offset:47616
  ds_read_b128 v[156:159], v173 offset:18560
  v_and_b32 v219, s60, v4
  s_waitcnt lgkmcnt(9)
  v_mfma_f32_32x32x16_bf16 v[16:31], v[128:131], v[132:135], v[16:31]
  ds_read_b64_tr_b16 v[160:161], v244 offset:49152
  ds_read_b64_tr_b16 v[162:163], v244 offset:49664
  ds_read_b128 v[164:167], v174 offset:192
  v_lshrrev_b32 v4, 2, v4
  s_waitcnt lgkmcnt(9)
  v_mfma_f32_32x32x16_bf16 v[16:31], v[136:139], v[140:143], v[16:31]
  ds_read_b64_tr_b16 v[128:129], v244 offset:51200
  ds_read_b64_tr_b16 v[130:131], v244 offset:51712
  ds_read_b128 v[132:135], v175 offset:192
  v_and_b32 v220, s60, v4
  s_waitcnt lgkmcnt(9)
  v_mfma_f32_32x32x16_bf16 v[16:31], v[144:147], v[148:151], v[16:31]
  ds_read_b64_tr_b16 v[136:137], v244 offset:53248
  ds_read_b64_tr_b16 v[138:139], v244 offset:53760
  ds_read_b128 v[140:143], v174 offset:6336
  v_lshrrev_b32 v4, 2, v4
  s_waitcnt lgkmcnt(9)
  v_mfma_f32_32x32x16_bf16 v[16:31], v[152:155], v[156:159], v[16:31]
  ds_read_b64_tr_b16 v[144:145], v244 offset:55296
  ds_read_b64_tr_b16 v[146:147], v244 offset:55808
  ds_read_b128 v[148:151], v175 offset:6336
  v_and_b32 v221, s60, v4
  s_waitcnt lgkmcnt(9)
  v_mfma_f32_32x32x16_bf16 v[16:31], v[160:163], v[164:167], v[16:31]
  s_barrier
  ds_read_b64_tr_b16 v[152:153], v244 offset:57344
  ds_read_b64_tr_b16 v[154:155], v244 offset:57856
  ds_read_b128 v[156:159], v174 offset:12480
  v_lshrrev_b32 v4, 2, v4
  s_waitcnt lgkmcnt(9)
  v_mfma_f32_32x32x16_bf16 v[16:31], v[128:131], v[132:135], v[16:31]
  ds_read_b64_tr_b16 v[160:161], v244 offset:59392
  ds_read_b64_tr_b16 v[162:163], v244 offset:59904
  ds_read_b128 v[164:167], v175 offset:12480
  v_and_b32 v222, s60, v4
  s_waitcnt lgkmcnt(9)
  v_mfma_f32_32x32x16_bf16 v[16:31], v[136:139], v[140:143], v[16:31]
  ds_read_b64_tr_b16 v[128:129], v244 offset:61440
  ds_read_b64_tr_b16 v[130:131], v244 offset:61952
  ds_read_b128 v[132:135], v174 offset:18624
  v_mad_u32_u24 v4, v2, 37, s84
  s_waitcnt lgkmcnt(9)
  v_mfma_f32_32x32x16_bf16 v[16:31], v[144:147], v[148:151], v[16:31]
  ds_read_b64_tr_b16 v[136:137], v244 offset:63488
  ds_read_b64_tr_b16 v[138:139], v244 offset:64000
  ds_read_b128 v[140:143], v175 offset:18624
  v_and_b32 v4, 0xff, v4
  s_waitcnt lgkmcnt(9)
  v_mfma_f32_32x32x16_bf16 v[16:31], v[152:155], v[156:159], v[16:31]
  ds_read_b64_tr_b16 v[144:145], v245 offset:0
  ds_read_b64_tr_b16 v[146:147], v245 offset:512
  ds_read_b128 v[148:151], v176 offset:256
  v_lshl_or_b32 v200, v4, 15, v4
  s_waitcnt lgkmcnt(9)
  v_mfma_f32_32x32x16_bf16 v[16:31], v[160:163], v[164:167], v[16:31]
  ds_read_b64_tr_b16 v[152:153], v245 offset:2048
  ds_read_b64_tr_b16 v[154:155], v245 offset:2560
  ds_read_b128 v[156:159], v177 offset:256
  v_lshrrev_b32 v201, 2, v200
  s_waitcnt lgkmcnt(9)
  v_mfma_f32_32x32x16_bf16 v[16:31], v[128:131], v[132:135], v[16:31]
  ds_read_b64_tr_b16 v[160:161], v245 offset:4096
  ds_read_b64_tr_b16 v[162:163], v245 offset:4608
  ds_read_b128 v[164:167], v176 offset:6400
  v_lshrrev_b32 v202, 4, v200
  s_waitcnt lgkmcnt(9)
  v_mfma_f32_32x32x16_bf16 v[16:31], v[136:139], v[140:143], v[16:31]
  ds_read_b64_tr_b16 v[128:129], v245 offset:6144
  ds_read_b64_tr_b16 v[130:131], v245 offset:6656
  ds_read_b128 v[132:135], v177 offset:6400
  v_lshrrev_b32 v203, 6, v200
  s_waitcnt lgkmcnt(9)
  v_mfma_f32_32x32x16_bf16 v[16:31], v[144:147], v[148:151], v[16:31]
  ds_read_b64_tr_b16 v[136:137], v245 offset:8192
  ds_read_b64_tr_b16 v[138:139], v245 offset:8704
  ds_read_b128 v[140:143], v176 offset:12544
  v_mov_b32 v232, s84
  s_waitcnt lgkmcnt(9)
  v_mfma_f32_32x32x16_bf16 v[16:31], v[152:155], v[156:159], v[16:31]
  ds_read_b64_tr_b16 v[144:145], v245 offset:10240
  ds_read_b64_tr_b16 v[146:147], v245 offset:10752
  ds_read_b128 v[148:151], v177 offset:12544
  v_and_b32 v251, s84, v251
  s_waitcnt lgkmcnt(9)
  v_mfma_f32_32x32x16_bf16 v[16:31], v[160:163], v[164:167], v[16:31]
  ds_read_b64_tr_b16 v[152:153], v245 offset:12288
  ds_read_b64_tr_b16 v[154:155], v245 offset:12800
  ds_read_b128 v[156:159], v176 offset:18688
  s_mov_b64 s[28:29], s[78:79]
  s_waitcnt lgkmcnt(9)
  v_mfma_f32_32x32x16_bf16 v[16:31], v[128:131], v[132:135], v[16:31]
  ds_read_b64_tr_b16 v[160:161], v245 offset:14336
  ds_read_b64_tr_b16 v[162:163], v245 offset:14848
  ds_read_b128 v[164:167], v177 offset:18688
  s_mov_b32 s30, 2048000
  s_waitcnt lgkmcnt(9)
  v_mfma_f32_32x32x16_bf16 v[16:31], v[136:139], v[140:143], v[16:31]
  ds_read_b64_tr_b16 v[128:129], v245 offset:16384
  ds_read_b64_tr_b16 v[130:131], v245 offset:16896
  ds_read_b128 v[132:135], v178 offset:320
  s_mov_b32 s31, 0x20000
  s_waitcnt lgkmcnt(9)
  v_mfma_f32_32x32x16_bf16 v[16:31], v[144:147], v[148:151], v[16:31]
  ds_read_b64_tr_b16 v[136:137], v245 offset:18432
  ds_read_b64_tr_b16 v[138:139], v245 offset:18944
  ds_read_b128 v[140:143], v179 offset:320
  s_mov_b32 s86, 0xffff0000
  s_waitcnt lgkmcnt(9)
  v_mfma_f32_32x32x16_bf16 v[16:31], v[152:155], v[156:159], v[16:31]
  ds_read_b64_tr_b16 v[144:145], v245 offset:20480
  ds_read_b64_tr_b16 v[146:147], v245 offset:20992
  ds_read_b128 v[148:151], v178 offset:6464
  v_lshlrev_b32 v4, 4, v1
  s_waitcnt lgkmcnt(9)
  v_mfma_f32_32x32x16_bf16 v[16:31], v[160:163], v[164:167], v[16:31]
  ds_read_b64_tr_b16 v[152:153], v245 offset:22528
  ds_read_b64_tr_b16 v[154:155], v245 offset:23040
  ds_read_b128 v[156:159], v179 offset:6464
  v_add_u32 v240, 141312, v4
  s_waitcnt lgkmcnt(9)
  v_mfma_f32_32x32x16_bf16 v[16:31], v[128:131], v[132:135], v[16:31]
  s_barrier
  ds_read_b64_tr_b16 v[160:161], v245 offset:24576
  ds_read_b64_tr_b16 v[162:163], v245 offset:25088
  ds_read_b128 v[164:167], v178 offset:12608
  s_lshl_b32 s54, s36, 10
  s_waitcnt lgkmcnt(9)
  v_mfma_f32_32x32x16_bf16 v[16:31], v[136:139], v[140:143], v[16:31]
  ds_read_b64_tr_b16 v[128:129], v245 offset:26624
  ds_read_b64_tr_b16 v[130:131], v245 offset:27136
  ds_read_b128 v[132:135], v179 offset:12608
  v_add_u32 v242, s54, v240
  s_waitcnt lgkmcnt(9)
  v_mfma_f32_32x32x16_bf16 v[16:31], v[144:147], v[148:151], v[16:31]
  ds_read_b64_tr_b16 v[136:137], v245 offset:28672
  ds_read_b64_tr_b16 v[138:139], v245 offset:29184
  ds_read_b128 v[140:143], v178 offset:18752
  v_lshrrev_b32 v4, 3, v2
  s_waitcnt lgkmcnt(9)
  v_mfma_f32_32x32x16_bf16 v[16:31], v[152:155], v[156:159], v[16:31]
  ds_read_b64_tr_b16 v[144:145], v245 offset:30720
  ds_read_b64_tr_b16 v[146:147], v245 offset:31232
  ds_read_b128 v[148:151], v179 offset:18752
  v_mul_u32_u24 v4, 576, v4
  s_waitcnt lgkmcnt(9)
  v_mfma_f32_32x32x16_bf16 v[16:31], v[160:163], v[164:167], v[16:31]
  ds_read_b64_tr_b16 v[152:153], v245 offset:32768
  ds_read_b64_tr_b16 v[154:155], v245 offset:33280
  ds_read_b128 v[156:159], v180 offset:384
  v_lshl_add_u32 v4, v3, 4, v4
  s_waitcnt lgkmcnt(9)
  v_mfma_f32_32x32x16_bf16 v[16:31], v[128:131], v[132:135], v[16:31]
  ds_read_b64_tr_b16 v[160:161], v245 offset:34816
  ds_read_b64_tr_b16 v[162:163], v245 offset:35328
  ds_read_b128 v[164:167], v181 offset:384
  v_add_u32 v238, 139264, v4
  s_waitcnt lgkmcnt(9)
  v_mfma_f32_32x32x16_bf16 v[16:31], v[136:139], v[140:143], v[16:31]
  ds_read_b64_tr_b16 v[128:129], v245 offset:36864
  ds_read_b64_tr_b16 v[130:131], v245 offset:37376
  ds_read_b128 v[132:135], v180 offset:6528
  s_lshr_b32 s87, s37, 2
  s_waitcnt lgkmcnt(9)
  v_mfma_f32_32x32x16_bf16 v[16:31], v[144:147], v[148:151], v[16:31]
  ds_read_b64_tr_b16 v[136:137], v245 offset:38912
  ds_read_b64_tr_b16 v[138:139], v245 offset:39424
  ds_read_b128 v[140:143], v181 offset:6528
  s_lshl_b32 s88, s87, 13
  s_waitcnt lgkmcnt(9)
  v_mfma_f32_32x32x16_bf16 v[16:31], v[152:155], v[156:159], v[16:31]
  ds_read_b64_tr_b16 v[144:145], v245 offset:40960
  ds_read_b64_tr_b16 v[146:147], v245 offset:41472
  ds_read_b128 v[148:151], v180 offset:12672
  s_lshl_b32 s47, s36, 10
  s_waitcnt lgkmcnt(9)
  v_mfma_f32_32x32x16_bf16 v[16:31], v[160:163], v[164:167], v[16:31]
  ds_read_b64_tr_b16 v[152:153], v245 offset:43008
  ds_read_b64_tr_b16 v[154:155], v245 offset:43520
  ds_read_b128 v[156:159], v181 offset:12672
  s_add_u32 s88, s88, s47
  s_waitcnt lgkmcnt(9)
  v_mfma_f32_32x32x16_bf16 v[16:31], v[128:131], v[132:135], v[16:31]
  ds_read_b64_tr_b16 v[160:161], v245 offset:45056
  ds_read_b64_tr_b16 v[162:163], v245 offset:45568
  ds_read_b128 v[164:167], v180 offset:18816
  s_add_u32 s88, s88, 8388608
  s_waitcnt lgkmcnt(9)
  v_mfma_f32_32x32x16_bf16 v[16:31], v[136:139], v[140:143], v[16:31]
  ds_read_b64_tr_b16 v[128:129], v245 offset:47104
  ds_read_b64_tr_b16 v[130:131], v245 offset:47616
  ds_read_b128 v[132:135], v181 offset:18816
  v_and_b32 v4, 7, v2
  s_waitcnt lgkmcnt(9)
  v_mfma_f32_32x32x16_bf16 v[16:31], v[144:147], v[148:151], v[16:31]
  ds_read_b64_tr_b16 v[136:137], v245 offset:49152
  ds_read_b64_tr_b16 v[138:139], v245 offset:49664
  ds_read_b128 v[140:143], v182 offset:448
  v_lshlrev_b32 v4, 4, v4
  s_waitcnt lgkmcnt(9)
  v_mfma_f32_32x32x16_bf16 v[16:31], v[152:155], v[156:159], v[16:31]
  ds_read_b64_tr_b16 v[144:145], v245 offset:51200
  ds_read_b64_tr_b16 v[146:147], v245 offset:51712
  ds_read_b128 v[148:151], v183 offset:448
  v_lshl_add_u32 v239, v3, 7, v4
  s_waitcnt lgkmcnt(9)
  v_mfma_f32_32x32x16_bf16 v[16:31], v[160:163], v[164:167], v[16:31]
  ds_read_b64_tr_b16 v[152:153], v245 offset:53248
  ds_read_b64_tr_b16 v[154:155], v245 offset:53760
  ds_read_b128 v[156:159], v182 offset:6592
  s_mul_i32 s89, s87, 250
  s_waitcnt lgkmcnt(9)
  v_mfma_f32_32x32x16_bf16 v[16:31], v[128:131], v[132:135], v[16:31]
  ds_read_b64_tr_b16 v[160:161], v245 offset:55296
  ds_read_b64_tr_b16 v[162:163], v245 offset:55808
  ds_read_b128 v[164:167], v183 offset:6592
  s_and_b32 s56, s37, 3
  s_waitcnt lgkmcnt(9)
  v_mfma_f32_32x32x16_bf16 v[16:31], v[136:139], v[140:143], v[16:31]
  s_waitcnt lgkmcnt(6)
  v_mfma_f32_32x32x16_bf16 v[16:31], v[144:147], v[148:151], v[16:31]
  s_waitcnt lgkmcnt(3)
  v_mfma_f32_32x32x16_bf16 v[16:31], v[152:155], v[156:159], v[16:31]
  s_waitcnt lgkmcnt(0)
  v_mfma_f32_32x32x16_bf16 v[16:31], v[160:163], v[164:167], v[16:31]
  s_nop 11
  v_perm_b32 v48, v17, v16, s62
  v_perm_b32 v49, v19, v18, s62
  v_perm_b32 v50, v25, v24, s62
  v_perm_b32 v51, v27, v26, s62
  v_add_u32 v48, s60, v48
  v_add_u32 v49, s60, v49
  v_add_u32 v50, s60, v50
  v_add_u32 v51, s60, v51
  v_and_or_b32 v48, v48, s61, v186
  v_and_or_b32 v49, v49, s61, v187
  v_and_or_b32 v50, v50, s61, v188
  v_and_or_b32 v51, v51, s61, v189
  buffer_store_dwordx4 v[48:51], v184, s[24:27], s15 offen sc1
  v_perm_b32 v52, v21, v20, s62
  v_perm_b32 v53, v23, v22, s62
  v_perm_b32 v54, v29, v28, s62
  v_perm_b32 v55, v31, v30, s62
  v_add_u32 v52, s60, v52
  v_add_u32 v53, s60, v53
  v_add_u32 v54, s60, v54
  v_add_u32 v55, s60, v55
  v_and_or_b32 v52, v52, s61, v186
  v_and_or_b32 v53, v53, s61, v187
  v_and_or_b32 v54, v54, s61, v188
  v_and_or_b32 v55, v55, s61, v189
  buffer_store_dwordx4 v[52:55], v184, s[24:27], s16 offen sc1
  s_setprio 0
  s_barrier
  ds_read_b64_tr_b16 v[64:65], v214 offset:0
  ds_read_b64_tr_b16 v[66:67], v214 offset:4096
  ds_read_b64_tr_b16 v[68:69], v214 offset:2048
  ds_read_b64_tr_b16 v[70:71], v214 offset:6144
  ds_read_b64_tr_b16 v[72:73], v214 offset:8192
  ds_read_b64_tr_b16 v[74:75], v214 offset:12288
  ds_read_b64_tr_b16 v[76:77], v214 offset:10240
  ds_read_b64_tr_b16 v[78:79], v214 offset:14336
  ds_read_b64_tr_b16 v[80:81], v214 offset:16384
  ds_read_b64_tr_b16 v[82:83], v214 offset:20480
  ds_read_b64_tr_b16 v[84:85], v214 offset:18432
  ds_read_b64_tr_b16 v[86:87], v214 offset:22528
  s_waitcnt lgkmcnt(4)
  ds_read_b64_tr_b16 v[88:89], v214 offset:24576
  ds_read_b64_tr_b16 v[90:91], v214 offset:28672
  ds_read_b64_tr_b16 v[92:93], v214 offset:26624
  ds_read_b64_tr_b16 v[94:95], v214 offset:30720
  ds_read_b64_tr_b16 v[96:97], v214 offset:32768
  ds_read_b64_tr_b16 v[98:99], v214 offset:36864
  ds_read_b64_tr_b16 v[100:101], v214 offset:34816
  ds_read_b64_tr_b16 v[102:103], v214 offset:38912
  ds_read_b64_tr_b16 v[104:105], v214 offset:40960
  ds_read_b64_tr_b16 v[106:107], v214 offset:45056
  ds_read_b64_tr_b16 v[108:109], v214 offset:43008
  ds_read_b64_tr_b16 v[110:111], v214 offset:47104
  s_waitcnt lgkmcnt(4)
  ds_read_b64_tr_b16 v[112:113], v214 offset:49152
  ds_read_b64_tr_b16 v[114:115], v214 offset:53248
  ds_read_b64_tr_b16 v[116:117], v214 offset:51200
  ds_read_b64_tr_b16 v[118:119], v214 offset:55296
  ds_read_b64_tr_b16 v[120:121], v214 offset:57344
  ds_read_b64_tr_b16 v[122:123], v214 offset:61440
  ds_read_b64_tr_b16 v[124:125], v214 offset:59392
  ds_read_b64_tr_b16 v[126:127], v214 offset:63488
  s_cmp_lg_u32 s36, 4
  s_cbranch_scc1 L_noarr
  v_mov_b32 v56, s84
  v_not_b32 v57, s84
  v_mov_b32 v58, s84
  v_not_b32 v59, s84
  s_lshl_b32 s48, s2, 4
  s_add_u32 s48, s48, 4096
  s_mov_b64 exec, 1
  buffer_store_dwordx4 v[56:59], v10, s[24:27], s48 offen sc1
  s_mov_b64 exec, -1
L_noarr:
  s_lshl_b32 s47, s56, 6
  s_add_u32 s89, s89, s47
  s_lshl1_add_u32 s89, s38, s89
  s_lshl_b32 s89, s89, 12
  s_lshl_b32 s47, s36, 6
  s_add_u32 s89, s89, s47
  v_lshlrev_b32 v4, 9, v2
  v_and_b32 v5, 1, v3
  v_lshl_add_u32 v4, v5, 5, v4
  v_lshrrev_b32 v5, 1, v3
  v_lshl_add_u32 v241, v5, 4, v4
  s_mov_b64 s[20:21], s[76:77]
  s_mov_b32 s22, 131072
  s_mov_b32 s23, 0x20000
  v_lshrrev_b32 v5, 5, v1
  v_and_b32 v6, 31, v1
  v_lshlrev_b32 v4, 1, v5
  v_xor_b32 v4, v4, v6
  s_and_b32 s54, s36, 1
  s_lshl_b32 s54, s54, 3
  v_xor_b32 v4, s54, v4
  s_lshl_b32 s52, s36, 11
  v_lshl_add_u32 v4, v4, 4, s52
  v_lshl_add_u32 v233, v5, 9, v4
  v_xor_b32 v234, 64, v233
  s_lshl_b32 s33, s37, 19
  s_lshl_b32 s47, s38, 14
  s_add_u32 s33, s33, s47
  s_lshl_b32 s47, s14, 8
  s_add_u32 s33, s33, s47
  s_add_u32 s33, s33, 4194304
  v_lshlrev_b32 v4, 10, v3
  v_lshl_add_u32 v236, v2, 4, v4
  v_and_b32 v4, 1, v2
  v_mul_u32_u24 v4, 576, v4
  v_lshrrev_b32 v5, 3, v2
  v_lshl_add_u32 v4, v5, 6, v4
  v_bfe_u32 v5, v2, 1, 1
  v_lshl_add_u32 v4, v5, 5, v4
  v_bfe_u32 v5, v2, 2, 1
  v_lshl_add_u32 v4, v5, 4, v4
  v_lshl_add_u32 v4, v3, 3, v4
  s_lshl_b32 s54, s14, 7
  s_add_u32 s54, s54, 139264
  v_add_u32 v237, s54, v4
  s_add_u32 s34, s33, 4096
  s_add_u32 s35, s33, 8192
  s_add_u32 s91, s33, 12288
  s_waitcnt lgkmcnt(0)
  s_barrier
  s_cmp_lg_u32 s57, 0
  s_cbranch_scc1 L_g1start
  ds_read_b64_tr_b16 v[128:129], v217 offset:0
  ds_read_b64_tr_b16 v[130:131], v217 offset:8192
  ds_read_b64_tr_b16 v[132:133], v218 offset:0
  ds_read_b64_tr_b16 v[134:135], v218 offset:8192
  ds_read_b64_tr_b16 v[136:137], v217 offset:16384
  ds_read_b64_tr_b16 v[138:139], v217 offset:24576
  ds_read_b64_tr_b16 v[140:141], v218 offset:16384
  ds_read_b64_tr_b16 v[142:143], v218 offset:24576
  s_waitcnt lgkmcnt(6)
L_g1start:
  s_setprio 2
  s_mov_b32 s90, 0
  s_waitcnt vmcnt(0)
L_g1:
  buffer_load_dwordx4 v[16:19], v225, s[24:27], s5 offen sc1
  buffer_load_dwordx4 v[20:23], v225, s[24:27], s6 offen sc1
  buffer_load_dwordx4 v[24:27], v225, s[24:27], s7 offen sc1
  buffer_load_dwordx4 v[28:31], v225, s[24:27], s8 offen sc1
  buffer_load_dwordx4 v[32:35], v226, s[24:27], s5 offen sc1
  s_add_u32 s90, s90, 1
  s_waitcnt vmcnt(4)
  v_xor_b32 v4, v16, v200
  v_and_b32 v16, s61, v16
  v_bitop3_b32 v4, v4, v17, v201 bitop3:0xf6
  v_and_b32 v17, s61, v17
  v_bitop3_b32 v4, v4, v18, v202 bitop3:0xf6
  v_and_b32 v18, s61, v18
  v_bitop3_b32 v4, v4, v19, v203 bitop3:0xf6
  v_and_b32 v19, s61, v19
  s_nop 1
  v_mfma_f32_16x16x32_bf16 v[36:39], v[192:195], v[16:19], 0
  s_waitcnt vmcnt(3)
  v_bitop3_b32 v4, v4, v20, v200 bitop3:0xf6
  v_and_b32 v20, s61, v20
  v_bitop3_b32 v4, v4, v21, v201 bitop3:0xf6
  v_and_b32 v21, s61, v21
  v_bitop3_b32 v4, v4, v22, v202 bitop3:0xf6
  v_and_b32 v22, s61, v22
  v_bitop3_b32 v4, v4, v23, v203 bitop3:0xf6
  v_and_b32 v23, s61, v23
  s_nop 1
  v_mfma_f32_16x16x32_bf16 v[36:39], v[196:199], v[20:23], v[36:39]
  s_waitcnt vmcnt(2)
  v_bitop3_b32 v4, v4, v24, v200 bitop3:0xf6
  v_and_b32 v24, s61, v24
  v_bitop3_b32 v4, v4, v25, v201 bitop3:0xf6
  v_and_b32 v25, s61, v25
  v_bitop3_b32 v4, v4, v26, v202 bitop3:0xf6
  v_and_b32 v26, s61, v26
  v_bitop3_b32 v4, v4, v27, v203 bitop3:0xf6
  v_and_b32 v27, s61, v27
  s_nop 1
  v_mfma_f32_16x16x32_bf16 v[40:43], v[192:195], v[24:27], 0
  s_waitcnt vmcnt(1)
  v_bitop3_b32 v4, v4, v28, v200 bitop3:0xf6
  v_and_b32 v28, s61, v28
  v_bitop3_b32 v4, v4, v29, v201 bitop3:0xf6
  v_and_b32 v29, s61, v29
  v_bitop3_b32 v4, v4, v30, v202 bitop3:0xf6
  v_and_b32 v30, s61, v30
  v_bitop3_b32 v4, v4, v31, v203 bitop3:0xf6
  v_and_b32 v31, s61, v31
  s_nop 1
  v_mfma_f32_16x16x32_bf16 v[40:43], v[196:199], v[28:31], v[40:43]
  s_waitcnt vmcnt(0)
  v_xor_b32 v5, v32, v200
  v_and_b32 v32, s61, v32
  v_bitop3_b32 v5, v5, v33, v201 bitop3:0xf6
  v_and_b32 v33, s61, v33
  v_bitop3_b32 v5, v5, v34, v202 bitop3:0xf6
  v_and_b32 v34, s61, v34
  v_bitop3_b32 v5, v5, v35, v203 bitop3:0xf6
  v_and_b32 v35, s61, v35
  s_nop 1
  v_mfma_f32_16x16x32_bf16 v[44:47], v[192:195], v[32:35], 0
  v_and_b32 v4, v4, v227
  v_and_or_b32 v4, v5, v228, v4
  v_cmp_ne_u32 vcc, 0, v4
  s_cmp_gt_u32 s90, 20000
  s_cbranch_scc1 L_g1ok
  s_cmp_lg_u64 vcc, 0
  s_cbranch_scc1 L_g1
L_g1ok:
  v_pk_mul_f32 v[48:49], v[36:37], v[36:37]
  v_pk_mul_f32 v[50:51], v[38:39], v[38:39]
  v_pk_mul_f32 v[52:53], v[40:41], v[40:41]
  v_pk_mul_f32 v[54:55], v[42:43], v[42:43]
  v_pk_mul_f32 v[56:57], v[44:45], v[44:45]
  v_pk_mul_f32 v[58:59], v[46:47], v[46:47]
  v_pk_fma_f32 v[48:49], v[48:49], s[82:83], v[246:247]
  v_pk_fma_f32 v[50:51], v[50:51], s[82:83], v[246:247]
  v_pk_fma_f32 v[52:53], v[52:53], s[82:83], v[246:247]
  v_pk_fma_f32 v[54:55], v[54:55], s[82:83], v[246:247]
  v_pk_fma_f32 v[56:57], v[56:57], s[82:83], v[246:247]
  v_pk_fma_f32 v[58:59], v[58:59], s[82:83], v[246:247]
  v_pk_mul_f32 v[48:49], v[48:49], v[36:37]
  v_pk_mul_f32 v[50:51], v[50:51], v[38:39]
  v_pk_mul_f32 v[52:53], v[52:53], v[40:41]
  v_pk_mul_f32 v[54:55], v[54:55], v[42:43]
  v_pk_mul_f32 v[56:57], v[56:57], v[44:45]
  v_pk_mul_f32 v[58:59], v[58:59], v[46:47]
  v_exp_f32 v48, v48
  v_exp_f32 v49, v49
  v_exp_f32 v50, v50
  v_exp_f32 v51, v51
  v_exp_f32 v52, v52
  v_exp_f32 v53, v53
  v_exp_f32 v54, v54
  v_exp_f32 v55, v55
  v_exp_f32 v56, v56
  v_exp_f32 v57, v57
  v_exp_f32 v58, v58
  v_exp_f32 v59, v59
  v_pk_add_f32 v[48:49], v[48:49], 1.0 op_sel_hi:[1,0]
  v_pk_add_f32 v[50:51], v[50:51], 1.0 op_sel_hi:[1,0]
  v_pk_add_f32 v[52:53], v[52:53], 1.0 op_sel_hi:[1,0]
  v_pk_add_f32 v[54:55], v[54:55], 1.0 op_sel_hi:[1,0]
  v_pk_add_f32 v[56:57], v[56:57], 1.0 op_sel_hi:[1,0]
  v_pk_add_f32 v[58:59], v[58:59], 1.0 op_sel_hi:[1,0]
  v_rcp_f32 v48, v48
  v_rcp_f32 v49, v49
  v_rcp_f32 v50, v50
  v_rcp_f32 v51, v51
  v_rcp_f32 v52, v52
  v_rcp_f32 v53, v53
  v_rcp_f32 v54, v54
  v_rcp_f32 v55, v55
  v_rcp_f32 v56, v56
  v_rcp_f32 v57, v57
  v_rcp_f32 v58, v58
  v_rcp_f32 v59, v59
  v_pk_mul_f32 v[36:37], v[36:37], v[48:49]
  v_pk_mul_f32 v[38:39], v[38:39], v[50:51]
  v_pk_mul_f32 v[40:41], v[40:41], v[52:53]
  v_pk_mul_f32 v[42:43], v[42:43], v[54:55]
  v_pk_mul_f32 v[44:45], v[44:45], v[56:57]
  v_pk_mul_f32 v[46:47], v[46:47], v[58:59]
  v_cvt_pk_bf16_f32 v48, v36, v37
  v_cvt_pk_bf16_f32 v49, v38, v39
  v_cvt_pk_bf16_f32 v50, v40, v41
  v_cvt_pk_bf16_f32 v51, v42, v43
  v_cvt_pk_bf16_f32 v52, v44, v45
  v_cvt_pk_bf16_f32 v53, v46, v47
  ds_write_b64 v229, v[48:49]
  ds_write_b64 v229, v[50:51] offset:32
  s_mov_b64 exec, 0x00ff00ff
  ds_write_b64 v230, v[52:53]
  s_mov_b64 exec, -1
  s_waitcnt lgkmcnt(0)
  s_barrier
  ds_read_b128 v[48:51], v231 offset:0
  ds_read_b128 v[52:55], v231 offset:2560
  ds_read_b128 v[56:59], v231 offset:32
  ds_read_b128 v[60:63], v231 offset:2592
  ds_read_b128 v[4:7], v231 offset:80
  ds_read_b128 v[8:11], v231 offset:2640
  s_waitcnt lgkmcnt(5)
  v_mfma_f32_32x32x16_bf16 v[16:31], v[64:67], v[48:51], 0
  ds_read_b128 v[12:15], v231 offset:112
  s_waitcnt lgkmcnt(5)
  v_mfma_f32_32x32x16_bf16 v[32:47], v[64:67], v[52:55], 0
  ds_read_b128 v[48:51], v231 offset:2672
  s_waitcnt lgkmcnt(5)
  v_mfma_f32_32x32x16_bf16 v[16:31], v[68:71], v[56:59], v[16:31]
  ds_read_b128 v[52:55], v231 offset:160
  s_waitcnt lgkmcnt(5)
  v_mfma_f32_32x32x16_bf16 v[32:47], v[68:71], v[60:63], v[32:47]
  ds_read_b128 v[56:59], v231 offset:2720
  s_waitcnt lgkmcnt(5)
  v_mfma_f32_32x32x16_bf16 v[16:31], v[72:75], v[4:7], v[16:31]
  ds_read_b128 v[60:63], v231 offset:192
  s_waitcnt lgkmcnt(5)
  v_mfma_f32_32x32x16_bf16 v[32:47], v[72:75], v[8:11], v[32:47]
  ds_read_b128 v[4:7], v231 offset:2752
  s_waitcnt lgkmcnt(5)
  v_mfma_f32_32x32x16_bf16 v[16:31], v[76:79], v[12:15], v[16:31]
  ds_read_b128 v[8:11], v231 offset:240
  s_waitcnt lgkmcnt(5)
  v_mfma_f32_32x32x16_bf16 v[32:47], v[76:79], v[48:51], v[32:47]
  ds_read_b128 v[12:15], v231 offset:2800
  s_waitcnt lgkmcnt(5)
  v_mfma_f32_32x32x16_bf16 v[16:31], v[80:83], v[52:55], v[16:31]
  ds_read_b128 v[48:51], v231 offset:272
  s_waitcnt lgkmcnt(5)
  v_mfma_f32_32x32x16_bf16 v[32:47], v[80:83], v[56:59], v[32:47]
  ds_read_b128 v[52:55], v231 offset:2832
  s_waitcnt lgkmcnt(5)
  v_mfma_f32_32x32x16_bf16 v[16:31], v[84:87], v[60:63], v[16:31]
  ds_read_b128 v[56:59], v231 offset:320
  s_waitcnt lgkmcnt(5)
  v_mfma_f32_32x32x16_bf16 v[32:47], v[84:87], v[4:7], v[32:47]
  ds_read_b128 v[60:63], v231 offset:2880
  s_waitcnt lgkmcnt(5)
  v_mfma_f32_32x32x16_bf16 v[16:31], v[88:91], v[8:11], v[16:31]
  ds_read_b128 v[4:7], v231 offset:352
  s_waitcnt lgkmcnt(5)
  v_mfma_f32_32x32x16_bf16 v[32:47], v[88:91], v[12:15], v[32:47]
  ds_read_b128 v[8:11], v231 offset:2912
  s_waitcnt lgkmcnt(5)
  v_mfma_f32_32x32x16_bf16 v[16:31], v[92:95], v[48:51], v[16:31]
  ds_read_b128 v[12:15], v231 offset:400
  s_waitcnt lgkmcnt(5)
  v_mfma_f32_32x32x16_bf16 v[32:47], v[92:95], v[52:55], v[32:47]
  ds_read_b128 v[48:51], v231 offset:2960
  s_waitcnt lgkmcnt(5)
  v_mfma_f32_32x32x16_bf16 v[16:31], v[96:99], v[56:59], v[16:31]
  ds_read_b128 v[52:55], v231 offset:432
  s_waitcnt lgkmcnt(5)
  v_mfma_f32_32x32x16_bf16 v[32:47], v[96:99], v[60:63], v[32:47]
  ds_read_b128 v[56:59], v231 offset:2992
  s_waitcnt lgkmcnt(5)
  v_mfma_f32_32x32x16_bf16 v[16:31], v[100:103], v[4:7], v[16:31]
  ds_read_b128 v[60:63], v231 offset:480
  s_waitcnt lgkmcnt(5)
  v_mfma_f32_32x32x16_bf16 v[32:47], v[100:103], v[8:11], v[32:47]
  ds_read_b128 v[4:7], v231 offset:3040
  s_waitcnt lgkmcnt(5)
  v_mfma_f32_32x32x16_bf16 v[16:31], v[104:107], v[12:15], v[16:31]
  ds_read_b128 v[8:11], v231 offset:512
  s_waitcnt lgkmcnt(5)
  v_mfma_f32_32x32x16_bf16 v[32:47], v[104:107], v[48:51], v[32:47]
  ds_read_b128 v[12:15], v231 offset:3072
  s_waitcnt lgkmcnt(5)
  v_mfma_f32_32x32x16_bf16 v[16:31], v[108:111], v[52:55], v[16:31]
  ds_read_b128 v[48:51], v231 offset:560
  s_waitcnt lgkmcnt(5)
  v_mfma_f32_32x32x16_bf16 v[32:47], v[108:111], v[56:59], v[32:47]
  ds_read_b128 v[52:55], v231 offset:3120
  s_waitcnt lgkmcnt(5)
  v_mfma_f32_32x32x16_bf16 v[16:31], v[112:115], v[60:63], v[16:31]
  ds_read_b128 v[56:59], v231 offset:592
  s_waitcnt lgkmcnt(5)
  v_mfma_f32_32x32x16_bf16 v[32:47], v[112:115], v[4:7], v[32:47]
  ds_read_b128 v[60:63], v231 offset:3152
  s_waitcnt lgkmcnt(5)
  v_mfma_f32_32x32x16_bf16 v[16:31], v[116:119], v[8:11], v[16:31]
  s_waitcnt lgkmcnt(4)
  v_mfma_f32_32x32x16_bf16 v[32:47], v[116:119], v[12:15], v[32:47]
  s_waitcnt lgkmcnt(3)
  v_mfma_f32_32x32x16_bf16 v[16:31], v[120:123], v[48:51], v[16:31]
  s_waitcnt lgkmcnt(2)
  v_mfma_f32_32x32x16_bf16 v[32:47], v[120:123], v[52:55], v[32:47]
  s_waitcnt lgkmcnt(1)
  v_mfma_f32_32x32x16_bf16 v[16:31], v[124:127], v[56:59], v[16:31]
  s_waitcnt lgkmcnt(0)
  v_mfma_f32_32x32x16_bf16 v[32:47], v[124:127], v[60:63], v[32:47]
  s_nop 9
  v_perm_b32 v4, v17, v16, s62
  v_perm_b32 v5, v19, v18, s62
  v_perm_b32 v6, v25, v24, s62
  v_perm_b32 v7, v27, v26, s62
  v_perm_b32 v8, v21, v20, s62
  v_perm_b32 v9, v23, v22, s62
  v_perm_b32 v10, v29, v28, s62
  v_perm_b32 v11, v31, v30, s62
  s_mov_b32 vcc_lo, 0x33333333
  s_mov_b32 vcc_hi, 0x33333333
  v_cndmask_b32_dpp v48, v8, v4, vcc quad_perm:[0,1,0,1] row_mask:0xf bank_mask:0xf
  v_cndmask_b32_dpp v49, v9, v5, vcc quad_perm:[0,1,0,1] row_mask:0xf bank_mask:0xf
  v_cndmask_b32_dpp v50, v10, v6, vcc quad_perm:[0,1,0,1] row_mask:0xf bank_mask:0xf
  v_cndmask_b32_dpp v51, v11, v7, vcc quad_perm:[0,1,0,1] row_mask:0xf bank_mask:0xf
  s_not_b64 vcc, vcc
  v_cndmask_b32_dpp v52, v4, v8, vcc quad_perm:[2,3,2,3] row_mask:0xf bank_mask:0xf
  v_cndmask_b32_dpp v53, v5, v9, vcc quad_perm:[2,3,2,3] row_mask:0xf bank_mask:0xf
  v_cndmask_b32_dpp v54, v6, v10, vcc quad_perm:[2,3,2,3] row_mask:0xf bank_mask:0xf
  v_cndmask_b32_dpp v55, v7, v11, vcc quad_perm:[2,3,2,3] row_mask:0xf bank_mask:0xf
  v_add_u32 v48, s60, v48
  v_add_u32 v49, s60, v49
  v_add_u32 v50, s60, v50
  v_add_u32 v51, s60, v51
  v_and_or_b32 v48, v48, s61, v219
  v_and_or_b32 v49, v49, s61, v220
  v_and_or_b32 v50, v50, s61, v221
  v_and_or_b32 v51, v51, s61, v222
  buffer_store_dwordx4 v[48:51], v223, s[24:27], s18 offen sc1
  v_add_u32 v52, s60, v52
  v_add_u32 v53, s60, v53
  v_add_u32 v54, s60, v54
  v_add_u32 v55, s60, v55
  v_and_or_b32 v52, v52, s61, v219
  v_and_or_b32 v53, v53, s61, v220
  v_and_or_b32 v54, v54, s61, v221
  v_and_or_b32 v55, v55, s61, v222
  buffer_store_dwordx4 v[52:55], v224, s[24:27], s18 offen sc1
  v_perm_b32 v4, v33, v32, s62
  v_perm_b32 v5, v35, v34, s62
  v_perm_b32 v6, v41, v40, s62
  v_perm_b32 v7, v43, v42, s62
  v_perm_b32 v8, v37, v36, s62
  v_perm_b32 v9, v39, v38, s62
  v_perm_b32 v10, v45, v44, s62
  v_perm_b32 v11, v47, v46, s62
  s_mov_b32 vcc_lo, 0x33333333
  s_mov_b32 vcc_hi, 0x33333333
  v_cndmask_b32_dpp v56, v8, v4, vcc quad_perm:[0,1,0,1] row_mask:0xf bank_mask:0xf
  v_cndmask_b32_dpp v57, v9, v5, vcc quad_perm:[0,1,0,1] row_mask:0xf bank_mask:0xf
  v_cndmask_b32_dpp v58, v10, v6, vcc quad_perm:[0,1,0,1] row_mask:0xf bank_mask:0xf
  v_cndmask_b32_dpp v59, v11, v7, vcc quad_perm:[0,1,0,1] row_mask:0xf bank_mask:0xf
  s_not_b64 vcc, vcc
  v_cndmask_b32_dpp v60, v4, v8, vcc quad_perm:[2,3,2,3] row_mask:0xf bank_mask:0xf
  v_cndmask_b32_dpp v61, v5, v9, vcc quad_perm:[2,3,2,3] row_mask:0xf bank_mask:0xf
  v_cndmask_b32_dpp v62, v6, v10, vcc quad_perm:[2,3,2,3] row_mask:0xf bank_mask:0xf
  v_cndmask_b32_dpp v63, v7, v11, vcc quad_perm:[2,3,2,3] row_mask:0xf bank_mask:0xf
  v_add_u32 v56, s60, v56
  v_add_u32 v57, s60, v57
  v_add_u32 v58, s60, v58
  v_add_u32 v59, s60, v59
  v_and_or_b32 v56, v56, s61, v219
  v_and_or_b32 v57, v57, s61, v220
  v_and_or_b32 v58, v58, s61, v221
  v_and_or_b32 v59, v59, s61, v222
  buffer_store_dwordx4 v[56:59], v223, s[24:27], s19 offen sc1
  v_add_u32 v60, s60, v60
  v_add_u32 v61, s60, v61
  v_add_u32 v62, s60, v62
  v_add_u32 v63, s60, v63
  v_and_or_b32 v60, v60, s61, v219
  v_and_or_b32 v61, v61, s61, v220
  v_and_or_b32 v62, v62, s61, v221
  v_and_or_b32 v63, v63, s61, v222
  buffer_store_dwordx4 v[60:63], v224, s[24:27], s19 offen sc1
  s_cmp_eq_u32 s57, 3
  s_cbranch_scc1 L_epoch
  s_cmp_lg_u32 s57, 0
  s_cbranch_scc1 L_fin
  s_barrier
  ds_read_b64_tr_b16 v[144:145], v217 offset:32768
  ds_read_b64_tr_b16 v[146:147], v217 offset:40960
  ds_read_b64_tr_b16 v[148:149], v218 offset:32768
  ds_read_b64_tr_b16 v[150:151], v218 offset:40960
  ds_read_b64_tr_b16 v[152:153], v217 offset:49152
  ds_read_b64_tr_b16 v[154:155], v217 offset:57344
  ds_read_b64_tr_b16 v[156:157], v218 offset:49152
  ds_read_b64_tr_b16 v[158:159], v218 offset:57344
  s_waitcnt lgkmcnt(6)
  ds_read_b64_tr_b16 v[160:161], v215 offset:0
  ds_read_b64_tr_b16 v[162:163], v215 offset:8192
  ds_read_b64_tr_b16 v[164:165], v216 offset:0
  ds_read_b64_tr_b16 v[166:167], v216 offset:8192
  ds_read_b64_tr_b16 v[168:169], v215 offset:16384
  ds_read_b64_tr_b16 v[170:171], v215 offset:24576
  ds_read_b64_tr_b16 v[172:173], v216 offset:16384
  ds_read_b64_tr_b16 v[174:175], v216 offset:24576
  s_waitcnt lgkmcnt(6)
  ds_read_b64_tr_b16 v[176:177], v215 offset:32768
  ds_read_b64_tr_b16 v[178:179], v215 offset:40960
  ds_read_b64_tr_b16 v[180:181], v216 offset:32768
  ds_read_b64_tr_b16 v[182:183], v216 offset:40960
  ds_read_b64_tr_b16 v[184:185], v215 offset:49152
  ds_read_b64_tr_b16 v[186:187], v215 offset:57344
  ds_read_b64_tr_b16 v[188:189], v216 offset:49152
  ds_read_b64_tr_b16 v[190:191], v216 offset:57344
  s_waitcnt lgkmcnt(6)
  s_waitcnt lgkmcnt(0)
  s_barrier
  s_mov_b32 s90, 0
  s_waitcnt vmcnt(0)
  s_barrier
  buffer_load_dwordx4 v[48:51], v236, s[24:27], s33 offen sc1
  buffer_load_dwordx4 v[52:55], v236, s[24:27], s34 offen sc1
  buffer_load_dwordx4 v[56:59], v236, s[24:27], s35 offen sc1
  buffer_load_dwordx4 v[60:63], v236, s[24:27], s91 offen sc1
  buffer_load_dwordx4 v[16:19], v239, s[24:27], s88 offen sc1
  buffer_load_dwordx4 v[20:23], v239, s[24:27], s88 offen offset:512 sc1
  ds_read_b64_tr_b16 v[96:97], v217 offset:0
  ds_read_b64_tr_b16 v[98:99], v217 offset:8192
  ds_read_b64_tr_b16 v[100:101], v218 offset:0
  ds_read_b64_tr_b16 v[102:103], v218 offset:8192
  ds_read_b64_tr_b16 v[104:105], v217 offset:16384
  ds_read_b64_tr_b16 v[106:107], v217 offset:24576
  ds_read_b64_tr_b16 v[108:109], v218 offset:16384
  ds_read_b64_tr_b16 v[110:111], v218 offset:24576
  s_waitcnt lgkmcnt(6)
  ds_read_b64_tr_b16 v[112:113], v217 offset:32768
  ds_read_b64_tr_b16 v[114:115], v217 offset:40960
  ds_read_b64_tr_b16 v[116:117], v218 offset:32768
  ds_read_b64_tr_b16 v[118:119], v218 offset:40960
  ds_read_b64_tr_b16 v[120:121], v217 offset:49152
  ds_read_b64_tr_b16 v[122:123], v217 offset:57344
  ds_read_b64_tr_b16 v[124:125], v218 offset:49152
  ds_read_b64_tr_b16 v[126:127], v218 offset:57344
  s_waitcnt lgkmcnt(6)
  s_branch L_g2b
L_g2:
  buffer_load_dwordx4 v[48:51], v236, s[24:27], s33 offen sc1
  buffer_load_dwordx4 v[52:55], v236, s[24:27], s34 offen sc1
  buffer_load_dwordx4 v[56:59], v236, s[24:27], s35 offen sc1
  buffer_load_dwordx4 v[60:63], v236, s[24:27], s91 offen sc1
  buffer_load_dwordx4 v[16:19], v239, s[24:27], s88 offen sc1
  buffer_load_dwordx4 v[20:23], v239, s[24:27], s88 offen offset:512 sc1
L_g2b:
  s_add_u32 s90, s90, 1
  s_waitcnt vmcnt(5)
  v_xor_b32 v4, v48, v200
  v_and_b32 v48, s61, v48
  v_bitop3_b32 v4, v4, v49, v201 bitop3:0xf6
  v_and_b32 v49, s61, v49
  v_bitop3_b32 v4, v4, v50, v202 bitop3:0xf6
  v_and_b32 v50, s61, v50
  v_bitop3_b32 v4, v4, v51, v203 bitop3:0xf6
  v_and_b32 v51, s61, v51
  s_nop 1
  v_mfma_f32_16x16x32_bf16 v[8:11], v[192:195], v[48:51], 0
  s_waitcnt vmcnt(4)
  v_bitop3_b32 v4, v4, v52, v200 bitop3:0xf6
  v_and_b32 v52, s61, v52
  v_bitop3_b32 v4, v4, v53, v201 bitop3:0xf6
  v_and_b32 v53, s61, v53
  v_bitop3_b32 v4, v4, v54, v202 bitop3:0xf6
  v_and_b32 v54, s61, v54
  v_bitop3_b32 v4, v4, v55, v203 bitop3:0xf6
  v_and_b32 v55, s61, v55
  s_nop 1
  v_mfma_f32_16x16x32_bf16 v[8:11], v[192:195], v[52:55], v[8:11]
  s_waitcnt vmcnt(3)
  v_bitop3_b32 v4, v4, v56, v200 bitop3:0xf6
  v_and_b32 v56, s61, v56
  v_bitop3_b32 v4, v4, v57, v201 bitop3:0xf6
  v_and_b32 v57, s61, v57
  v_bitop3_b32 v4, v4, v58, v202 bitop3:0xf6
  v_and_b32 v58, s61, v58
  v_bitop3_b32 v4, v4, v59, v203 bitop3:0xf6
  v_and_b32 v59, s61, v59
  s_nop 1
  v_mfma_f32_16x16x32_bf16 v[8:11], v[192:195], v[56:59], v[8:11]
  s_waitcnt vmcnt(2)
  v_bitop3_b32 v4, v4, v60, v200 bitop3:0xf6
  v_and_b32 v60, s61, v60
  v_bitop3_b32 v4, v4, v61, v201 bitop3:0xf6
  v_and_b32 v61, s61, v61
  v_bitop3_b32 v4, v4, v62, v202 bitop3:0xf6
  v_and_b32 v62, s61, v62
  v_bitop3_b32 v4, v4, v63, v203 bitop3:0xf6
  v_and_b32 v63, s61, v63
  s_nop 1
  v_mfma_f32_16x16x32_bf16 v[8:11], v[192:195], v[60:63], v[8:11]
  s_waitcnt vmcnt(0)
  v_xor_b32 v5, s85, v16
  v_bitop3_b32 v5, v5, v17, s85 bitop3:0xf6
  v_bitop3_b32 v5, v5, v18, s85 bitop3:0xf6
  v_bitop3_b32 v5, v5, v19, s85 bitop3:0xf6
  v_bitop3_b32 v5, v5, v20, s85 bitop3:0xf6
  v_bitop3_b32 v5, v5, v21, s85 bitop3:0xf6
  v_bitop3_b32 v5, v5, v22, s85 bitop3:0xf6
  v_bitop3_b32 v5, v5, v23, s85 bitop3:0xf6
  v_and_b32 v5, 0xffff, v5
  v_and_or_b32 v4, v4, s60, v5
  v_cmp_ne_u32 vcc, 0, v4
  s_cmp_gt_u32 s90, 20000
  s_cbranch_scc1 L_g2ok
  s_cmp_lg_u64 vcc, 0
  s_cbranch_scc1 L_g2
L_g2ok:
  v_pk_mul_f32 v[48:49], v[8:9], v[8:9]
  v_pk_mul_f32 v[50:51], v[10:11], v[10:11]
  v_pk_fma_f32 v[48:49], v[48:49], s[82:83], v[246:247]
  v_pk_fma_f32 v[50:51], v[50:51], s[82:83], v[246:247]
  v_pk_mul_f32 v[48:49], v[48:49], v[8:9]
  v_pk_mul_f32 v[50:51], v[50:51], v[10:11]
  v_exp_f32 v48, v48
  v_exp_f32 v49, v49
  v_exp_f32 v50, v50
  v_exp_f32 v51, v51
  v_pk_add_f32 v[48:49], v[48:49], 1.0 op_sel_hi:[1,0]
  v_pk_add_f32 v[50:51], v[50:51], 1.0 op_sel_hi:[1,0]
  v_rcp_f32 v48, v48
  v_rcp_f32 v49, v49
  v_rcp_f32 v50, v50
  v_rcp_f32 v51, v51
  v_pk_mul_f32 v[8:9], v[8:9], v[48:49]
  v_pk_mul_f32 v[10:11], v[10:11], v[50:51]
  v_cvt_pk_bf16_f32 v52, v8, v9
  v_cvt_pk_bf16_f32 v53, v10, v11
  s_mov_b32 exec_hi, 0
  ds_write_b64 v237, v[52:53]
  s_mov_b64 exec, -1
  v_and_b32 v16, s86, v16
  v_and_b32 v17, s86, v17
  v_and_b32 v18, s86, v18
  v_and_b32 v19, s86, v19
  v_and_b32 v20, s86, v20
  v_and_b32 v21, s86, v21
  v_and_b32 v22, s86, v22
  v_and_b32 v23, s86, v23
  s_setprio 0
L_join2:
  s_nop 1
  s_waitcnt lgkmcnt(0)
  s_barrier
  ds_read_b128 v[32:35], v238 offset:0
  ds_read_b128 v[36:39], v238 offset:64
  ds_read_b128 v[40:43], v238 offset:128
  ds_read_b128 v[44:47], v238 offset:192
  ds_read_b128 v[48:51], v238 offset:256
  ds_read_b128 v[52:55], v238 offset:320
  ds_read_b128 v[56:59], v238 offset:384
  ds_read_b128 v[60:63], v238 offset:448
  s_add_u32 m0, s52, 0
  s_mov_b32 s48, 0
  buffer_load_dwordx4 v233, s[20:23], s48 offen offset:0 lds
  buffer_load_dwordx4 v234, s[20:23], s48 offen offset:1024 lds
  s_add_u32 m0, s52, 16384
  s_mov_b32 s48, 16384
  buffer_load_dwordx4 v233, s[20:23], s48 offen offset:0 lds
  buffer_load_dwordx4 v234, s[20:23], s48 offen offset:1024 lds
  s_waitcnt lgkmcnt(7)
  v_mfma_f32_16x16x32_bf16 v[16:19], v[128:131], v[32:35], v[16:19]
  v_mfma_f32_16x16x32_bf16 v[20:23], v[132:135], v[32:35], v[20:23]
  s_waitcnt lgkmcnt(6)
  v_mfma_f32_16x16x32_bf16 v[16:19], v[136:139], v[36:39], v[16:19]
  v_mfma_f32_16x16x32_bf16 v[20:23], v[140:143], v[36:39], v[20:23]
  s_waitcnt lgkmcnt(5)
  v_mfma_f32_16x16x32_bf16 v[16:19], v[144:147], v[40:43], v[16:19]
  v_mfma_f32_16x16x32_bf16 v[20:23], v[148:151], v[40:43], v[20:23]
  s_waitcnt lgkmcnt(0)
  v_mfma_f32_16x16x32_bf16 v[16:19], v[152:155], v[44:47], v[16:19]
  v_mfma_f32_16x16x32_bf16 v[20:23], v[156:159], v[44:47], v[20:23]
  s_add_u32 m0, s52, 32768
  s_mov_b32 s48, 32768
  buffer_load_dwordx4 v233, s[20:23], s48 offen offset:0 lds
  buffer_load_dwordx4 v234, s[20:23], s48 offen offset:1024 lds
  s_waitcnt lgkmcnt(8)
  ds_read_b64_tr_b16 v[88:89], v215 offset:49152
  ds_read_b64_tr_b16 v[90:91], v215 offset:57344
  ds_read_b64_tr_b16 v[92:93], v216 offset:49152
  ds_read_b64_tr_b16 v[94:95], v216 offset:57344
  v_mfma_f32_16x16x32_bf16 v[16:19], v[160:163], v[48:51], v[16:19]
  v_mfma_f32_16x16x32_bf16 v[20:23], v[164:167], v[48:51], v[20:23]
  v_mfma_f32_16x16x32_bf16 v[16:19], v[168:171], v[52:55], v[16:19]
  v_mfma_f32_16x16x32_bf16 v[20:23], v[172:175], v[52:55], v[20:23]
  v_mfma_f32_16x16x32_bf16 v[16:19], v[176:179], v[56:59], v[16:19]
  v_mfma_f32_16x16x32_bf16 v[20:23], v[180:183], v[56:59], v[20:23]
  v_mfma_f32_16x16x32_bf16 v[16:19], v[184:187], v[60:63], v[16:19]
  v_mfma_f32_16x16x32_bf16 v[20:23], v[188:191], v[60:63], v[20:23]
  s_mov_b32 s82, 0x4038aa3b
  s_nop 5
  v_pk_mul_f32 v[16:17], v[16:17], s[82:83] op_sel_hi:[1,0]
  v_pk_mul_f32 v[18:19], v[18:19], s[82:83] op_sel_hi:[1,0]
  v_pk_mul_f32 v[20:21], v[20:21], s[82:83] op_sel_hi:[1,0]
  v_pk_mul_f32 v[22:23], v[22:23], s[82:83] op_sel_hi:[1,0]
  v_exp_f32 v16, v16
  v_exp_f32 v17, v17
  v_exp_f32 v18, v18
  v_exp_f32 v19, v19
  v_exp_f32 v20, v20
  v_exp_f32 v21, v21
  v_exp_f32 v22, v22
  v_exp_f32 v23, v23
  v_pk_add_f32 v[16:17], v[16:17], 1.0 op_sel_hi:[1,0]
  v_pk_add_f32 v[18:19], v[18:19], 1.0 op_sel_hi:[1,0]
  v_pk_add_f32 v[20:21], v[20:21], 1.0 op_sel_hi:[1,0]
  v_pk_add_f32 v[22:23], v[22:23], 1.0 op_sel_hi:[1,0]
  v_rcp_f32 v16, v16
  v_rcp_f32 v17, v17
  v_rcp_f32 v18, v18
  v_rcp_f32 v19, v19
  v_rcp_f32 v20, v20
  v_rcp_f32 v21, v21
  v_rcp_f32 v22, v22
  v_rcp_f32 v23, v23
  v_pk_fma_f32 v[16:17], v[16:17], -2.0, 1.0 op_sel_hi:[1,0,0]
  v_pk_fma_f32 v[18:19], v[18:19], -2.0, 1.0 op_sel_hi:[1,0,0]
  v_pk_fma_f32 v[20:21], v[20:21], -2.0, 1.0 op_sel_hi:[1,0,0]
  v_pk_fma_f32 v[22:23], v[22:23], -2.0, 1.0 op_sel_hi:[1,0,0]
  v_cvt_pk_bf16_f32 v24, v16, v17
  v_cvt_pk_bf16_f32 v25, v18, v19
  v_cvt_pk_bf16_f32 v26, v20, v21
  v_cvt_pk_bf16_f32 v27, v22, v23
  ds_write_b128 v242, v[24:27]
  s_waitcnt vmcnt(0) lgkmcnt(0)
  s_barrier
  ds_read_b128 v[44:47], v240 offset:3072
  ds_read_b128 v[48:51], v240 offset:4096
  ds_read_b128 v[52:55], v240 offset:5120
  ds_read_b128 v[56:59], v240 offset:6144
  ds_read_b128 v[60:63], v240 offset:7168
  ds_read_b128 v[32:35], v240 offset:0
  ds_read_b64_tr_b16 v[64:65], v215 offset:0
  ds_read_b64_tr_b16 v[66:67], v215 offset:8192
  ds_read_b64_tr_b16 v[68:69], v216 offset:0
  ds_read_b64_tr_b16 v[70:71], v216 offset:8192
  ds_read_b128 v[36:39], v240 offset:1024
  ds_read_b64_tr_b16 v[72:73], v215 offset:16384
  ds_read_b64_tr_b16 v[74:75], v215 offset:24576
  ds_read_b64_tr_b16 v[76:77], v216 offset:16384
  s_waitcnt lgkmcnt(13)
  v_mfma_f32_16x16x32_bf16 v[16:19], v[88:91], v[44:47], 0
  v_mfma_f32_16x16x32_bf16 v[20:23], v[92:95], v[44:47], 0
  ds_read_b64_tr_b16 v[78:79], v216 offset:24576
  s_waitcnt lgkmcnt(13)
  v_mfma_f32_16x16x32_bf16 v[16:19], v[96:99], v[48:51], v[16:19]
  v_mfma_f32_16x16x32_bf16 v[20:23], v[100:103], v[48:51], v[20:23]
  ds_read_b128 v[40:43], v240 offset:2048
  s_waitcnt lgkmcnt(13)
  v_mfma_f32_16x16x32_bf16 v[16:19], v[104:107], v[52:55], v[16:19]
  v_mfma_f32_16x16x32_bf16 v[20:23], v[108:111], v[52:55], v[20:23]
  ds_read_b64_tr_b16 v[80:81], v215 offset:32768
  s_waitcnt lgkmcnt(13)
  v_mfma_f32_16x16x32_bf16 v[16:19], v[112:115], v[56:59], v[16:19]
  v_mfma_f32_16x16x32_bf16 v[20:23], v[116:119], v[56:59], v[20:23]
  ds_read_b64_tr_b16 v[82:83], v215 offset:40960
  s_waitcnt lgkmcnt(13)
  v_mfma_f32_16x16x32_bf16 v[16:19], v[120:123], v[60:63], v[16:19]
  v_mfma_f32_16x16x32_bf16 v[20:23], v[124:127], v[60:63], v[20:23]
  ds_read_b64_tr_b16 v[84:85], v216 offset:32768
  s_waitcnt lgkmcnt(9)
  v_mfma_f32_16x16x32_bf16 v[16:19], v[64:67], v[32:35], v[16:19]
  v_mfma_f32_16x16x32_bf16 v[20:23], v[68:71], v[32:35], v[20:23]
  ds_read_b64_tr_b16 v[86:87], v216 offset:40960
  s_waitcnt lgkmcnt(5)
  v_mfma_f32_16x16x32_bf16 v[16:19], v[72:75], v[36:39], v[16:19]
  v_mfma_f32_16x16x32_bf16 v[20:23], v[76:79], v[36:39], v[20:23]
  s_waitcnt lgkmcnt(0)
  v_mfma_f32_16x16x32_bf16 v[16:19], v[80:83], v[40:43], v[16:19]
  v_mfma_f32_16x16x32_bf16 v[20:23], v[84:87], v[40:43], v[20:23]
  s_nop 6
  v_cvt_pk_bf16_f32 v24, v16, v17
  v_cvt_pk_bf16_f32 v25, v18, v19
  v_cvt_pk_bf16_f32 v26, v20, v21
  v_cvt_pk_bf16_f32 v27, v22, v23
  s_nop 0
  v_permlane16_swap_b32 v24, v26
  v_permlane16_swap_b32 v25, v27
  buffer_store_dwordx4 v[24:27], v241, s[28:31], s89 offen sc1 nt
  s_branch L_fin
L_Lspecial:
  s_cmp_lg_u32 s57, 1
  s_cbranch_scc1 L_fin
  s_cmp_ge_u32 s36, 2
  s_cbranch_scc1 L_fin
  s_mov_b64 s[16:17], s[74:75]
  v_lshrrev_b32 v4, 2, v1
  v_and_b32 v5, 3, v1
  s_lshl_b32 s54, s58, 7
  s_lshl_b32 s47, s36, 6
  s_add_u32 s54, s54, s47
  v_lshl_add_u32 v5, v5, 4, s54
  v_lshl_add_u32 v8, v4, 9, v5
  v_add_u32 v9, 7168, v8
  v_add_u32 v10, 14336, v8
  v_add_u32 v11, 21504, v8
  s_lshl_b32 s56, s36, 14
  s_add_u32 m0, s56, 98304
  s_mov_b32 s53, 0
  buffer_load_dwordx4 v8, s[16:19], s53 offen offset:0 lds
  buffer_load_dwordx4 v9, s[16:19], s53 offen offset:1024 lds
  buffer_load_dwordx4 v10, s[16:19], s53 offen offset:2048 lds
  buffer_load_dwordx4 v11, s[16:19], s53 offen offset:3072 lds
  s_add_u32 m0, s56, 102400
  s_mov_b32 s53, 32768
  buffer_load_dwordx4 v8, s[16:19], s53 offen offset:0 lds
  buffer_load_dwordx4 v9, s[16:19], s53 offen offset:1024 lds
  buffer_load_dwordx4 v10, s[16:19], s53 offen offset:2048 lds
  buffer_load_dwordx4 v11, s[16:19], s53 offen offset:3072 lds
  s_add_u32 m0, s56, 106496
  s_mov_b32 s53, 65536
  buffer_load_dwordx4 v8, s[16:19], s53 offen offset:0 lds
  buffer_load_dwordx4 v9, s[16:19], s53 offen offset:1024 lds
  buffer_load_dwordx4 v10, s[16:19], s53 offen offset:2048 lds
  buffer_load_dwordx4 v11, s[16:19], s53 offen offset:3072 lds
  s_add_u32 m0, s56, 110592
  s_mov_b32 s53, 98304
  buffer_load_dwordx4 v8, s[16:19], s53 offen offset:0 lds
  buffer_load_dwordx4 v9, s[16:19], s53 offen offset:1024 lds
  buffer_load_dwordx4 v10, s[16:19], s53 offen offset:2048 lds
  buffer_load_dwordx4 v11, s[16:19], s53 offen offset:3072 lds
  s_barrier
  v_lshrrev_b32 v7, 5, v1
  v_bfe_u32 v8, v1, 2, 2
  v_lshl_add_u32 v4, v7, 3, v8
  s_add_u32 s56, s56, 98304
  v_lshl_add_u32 v4, v4, 6, s56
  v_bfe_u32 v5, v1, 4, 1
  v_lshl_add_u32 v4, v5, 5, v4
  v_and_b32 v5, 3, v1
  v_lshl_add_u32 v244, v5, 3, v4
  v_xor_b32 v6, v7, v2
  v_lshlrev_b32 v6, 4, v6
  v_lshl_add_u32 v6, v2, 9, v6
  v_add_u32 v6, 155648, v6
  s_waitcnt vmcnt(12)
  v_xor_b32 v5, 0, v6
  ds_read_b64_tr_b16 v[128:129], v244 offset:0
  ds_read_b64_tr_b16 v[130:131], v244 offset:256
  ds_read_b128 v[132:135], v5
  v_xor_b32 v5, 32, v6
  ds_read_b64_tr_b16 v[136:137], v244 offset:1024
  ds_read_b64_tr_b16 v[138:139], v244 offset:1280
  ds_read_b128 v[140:143], v5
  v_xor_b32 v5, 64, v6
  ds_read_b64_tr_b16 v[144:145], v244 offset:2048
  ds_read_b64_tr_b16 v[146:147], v244 offset:2304
  ds_read_b128 v[148:151], v5
  v_xor_b32 v5, 96, v6
  ds_read_b64_tr_b16 v[152:153], v244 offset:3072
  ds_read_b64_tr_b16 v[154:155], v244 offset:3328
  ds_read_b128 v[156:159], v5
  s_waitcnt lgkmcnt(9)
  v_mfma_f32_32x32x16_bf16 v[16:31], v[128:131], v[132:135], 0
  s_waitcnt lgkmcnt(6)
  v_mfma_f32_32x32x16_bf16 v[16:31], v[136:139], v[140:143], v[16:31]
  s_waitcnt lgkmcnt(3)
  v_mfma_f32_32x32x16_bf16 v[16:31], v[144:147], v[148:151], v[16:31]
  s_waitcnt lgkmcnt(0)
  v_mfma_f32_32x32x16_bf16 v[16:31], v[152:155], v[156:159], v[16:31]
  s_waitcnt vmcnt(8)
  v_xor_b32 v5, 128, v6
  ds_read_b64_tr_b16 v[128:129], v244 offset:4096
  ds_read_b64_tr_b16 v[130:131], v244 offset:4352
  ds_read_b128 v[132:135], v5
  v_xor_b32 v5, 160, v6
  ds_read_b64_tr_b16 v[136:137], v244 offset:5120
  ds_read_b64_tr_b16 v[138:139], v244 offset:5376
  ds_read_b128 v[140:143], v5
  v_xor_b32 v5, 192, v6
  ds_read_b64_tr_b16 v[144:145], v244 offset:6144
  ds_read_b64_tr_b16 v[146:147], v244 offset:6400
  ds_read_b128 v[148:151], v5
  v_xor_b32 v5, 224, v6
  ds_read_b64_tr_b16 v[152:153], v244 offset:7168
  ds_read_b64_tr_b16 v[154:155], v244 offset:7424
  ds_read_b128 v[156:159], v5
  s_waitcnt lgkmcnt(9)
  v_mfma_f32_32x32x16_bf16 v[16:31], v[128:131], v[132:135], v[16:31]
  s_waitcnt lgkmcnt(6)
  v_mfma_f32_32x32x16_bf16 v[16:31], v[136:139], v[140:143], v[16:31]
  s_waitcnt lgkmcnt(3)
  v_mfma_f32_32x32x16_bf16 v[16:31], v[144:147], v[148:151], v[16:31]
  s_waitcnt lgkmcnt(0)
  v_mfma_f32_32x32x16_bf16 v[16:31], v[152:155], v[156:159], v[16:31]
  s_waitcnt vmcnt(4)
  v_xor_b32 v5, 256, v6
  ds_read_b64_tr_b16 v[128:129], v244 offset:8192
  ds_read_b64_tr_b16 v[130:131], v244 offset:8448
  ds_read_b128 v[132:135], v5
  v_xor_b32 v5, 288, v6
  ds_read_b64_tr_b16 v[136:137], v244 offset:9216
  ds_read_b64_tr_b16 v[138:139], v244 offset:9472
  ds_read_b128 v[140:143], v5
  v_xor_b32 v5, 320, v6
  ds_read_b64_tr_b16 v[144:145], v244 offset:10240
  ds_read_b64_tr_b16 v[146:147], v244 offset:10496
  ds_read_b128 v[148:151], v5
  v_xor_b32 v5, 352, v6
  ds_read_b64_tr_b16 v[152:153], v244 offset:11264
  ds_read_b64_tr_b16 v[154:155], v244 offset:11520
  ds_read_b128 v[156:159], v5
  s_waitcnt lgkmcnt(9)
  v_mfma_f32_32x32x16_bf16 v[16:31], v[128:131], v[132:135], v[16:31]
  s_waitcnt lgkmcnt(6)
  v_mfma_f32_32x32x16_bf16 v[16:31], v[136:139], v[140:143], v[16:31]
  s_waitcnt lgkmcnt(3)
  v_mfma_f32_32x32x16_bf16 v[16:31], v[144:147], v[148:151], v[16:31]
  s_waitcnt lgkmcnt(0)
  v_mfma_f32_32x32x16_bf16 v[16:31], v[152:155], v[156:159], v[16:31]
  s_waitcnt vmcnt(0)
  v_xor_b32 v5, 384, v6
  ds_read_b64_tr_b16 v[128:129], v244 offset:12288
  ds_read_b64_tr_b16 v[130:131], v244 offset:12544
  ds_read_b128 v[132:135], v5
  v_xor_b32 v5, 416, v6
  ds_read_b64_tr_b16 v[136:137], v244 offset:13312
  ds_read_b64_tr_b16 v[138:139], v244 offset:13568
  ds_read_b128 v[140:143], v5
  v_xor_b32 v5, 448, v6
  ds_read_b64_tr_b16 v[144:145], v244 offset:14336
  ds_read_b64_tr_b16 v[146:147], v244 offset:14592
  ds_read_b128 v[148:151], v5
  v_xor_b32 v5, 480, v6
  ds_read_b64_tr_b16 v[152:153], v244 offset:15360
  ds_read_b64_tr_b16 v[154:155], v244 offset:15616
  ds_read_b128 v[156:159], v5
  s_waitcnt lgkmcnt(9)
  v_mfma_f32_32x32x16_bf16 v[16:31], v[128:131], v[132:135], v[16:31]
  s_waitcnt lgkmcnt(6)
  v_mfma_f32_32x32x16_bf16 v[16:31], v[136:139], v[140:143], v[16:31]
  s_waitcnt lgkmcnt(3)
  v_mfma_f32_32x32x16_bf16 v[16:31], v[144:147], v[148:151], v[16:31]
  s_waitcnt lgkmcnt(0)
  v_mfma_f32_32x32x16_bf16 v[16:31], v[152:155], v[156:159], v[16:31]
  s_lshl_b32 s48, s58, 11
  s_lshl_b32 s47, s36, 10
  s_add_u32 s48, s48, s47
  s_add_u32 s48, s48, 8388608
  s_and_b32 s85, s84, 0xffff
  v_and_b32 v6, 7, v1
  v_lshlrev_b32 v4, 4, v6
  v_lshl_add_u32 v4, v7, 7, v4
  v_bfe_u32 v6, v1, 3, 1
  v_lshl_add_u32 v4, v6, 13, v4
  s_nop 1
  v_cvt_pk_bf16_f32 v48, v16, v16
  v_cvt_pk_bf16_f32 v49, v17, v17
  v_cvt_pk_bf16_f32 v50, v18, v18
  v_cvt_pk_bf16_f32 v51, v19, v19
  v_cvt_pk_bf16_f32 v52, v20, v20
  v_cvt_pk_bf16_f32 v53, v21, v21
  v_cvt_pk_bf16_f32 v54, v22, v22
  v_cvt_pk_bf16_f32 v55, v23, v23
  v_cvt_pk_bf16_f32 v56, v24, v24
  v_cvt_pk_bf16_f32 v57, v25, v25
  v_cvt_pk_bf16_f32 v58, v26, v26
  v_cvt_pk_bf16_f32 v59, v27, v27
  v_cvt_pk_bf16_f32 v60, v28, v28
  v_cvt_pk_bf16_f32 v61, v29, v29
  v_cvt_pk_bf16_f32 v62, v30, v30
  v_cvt_pk_bf16_f32 v63, v31, v31
  v_lshl_or_b32 v48, v48, 16, s85
  v_lshl_or_b32 v49, v49, 16, s85
  v_lshl_or_b32 v50, v50, 16, s85
  v_lshl_or_b32 v51, v51, 16, s85
  v_lshl_or_b32 v52, v52, 16, s85
  v_lshl_or_b32 v53, v53, 16, s85
  v_lshl_or_b32 v54, v54, 16, s85
  v_lshl_or_b32 v55, v55, 16, s85
  v_lshl_or_b32 v56, v56, 16, s85
  v_lshl_or_b32 v57, v57, 16, s85
  v_lshl_or_b32 v58, v58, 16, s85
  v_lshl_or_b32 v59, v59, 16, s85
  v_lshl_or_b32 v60, v60, 16, s85
  v_lshl_or_b32 v61, v61, 16, s85
  v_lshl_or_b32 v62, v62, 16, s85
  v_lshl_or_b32 v63, v63, 16, s85
  s_mov_b32 exec_lo, 0xffff
  s_mov_b32 exec_hi, 0xffff
  buffer_store_dwordx4 v[48:51], v4, s[24:27], s48 offen offset:0 sc1
  buffer_store_dwordx4 v[52:55], v4, s[24:27], s48 offen offset:256 sc1
  buffer_store_dwordx4 v[56:59], v4, s[24:27], s48 offen offset:512 sc1
  buffer_store_dwordx4 v[60:63], v4, s[24:27], s48 offen offset:768 sc1
  s_mov_b64 exec, -1
  s_branch L_fin
L_epoch:
  s_cmp_lg_u32 s36, 4
  s_cbranch_scc1 L_fin
  v_lshlrev_b32 v4, 4, v1
  v_add_u32 v4, 4096, v4
  s_not_b32 s49, s84
  s_mov_b32 s90, 0
L_ep:
  buffer_load_dwordx4 v[32:35], v4, s[24:27], 0 offen offset:0 sc1
  buffer_load_dwordx4 v[36:39], v4, s[24:27], 0 offen offset:1024 sc1
  buffer_load_dwordx4 v[40:43], v4, s[24:27], 0 offen offset:2048 sc1
  buffer_load_dwordx4 v[44:47], v4, s[24:27], 0 offen offset:3072 sc1
  s_add_u32 s90, s90, 1
  s_waitcnt vmcnt(0)
  v_xor_b32 v5, s84, v32
  v_bitop3_b32 v5, v5, v33, s49 bitop3:0xf6
  v_bitop3_b32 v5, v5, v34, s84 bitop3:0xf6
  v_bitop3_b32 v5, v5, v35, s49 bitop3:0xf6
  v_bitop3_b32 v5, v5, v36, s84 bitop3:0xf6
  v_bitop3_b32 v5, v5, v37, s49 bitop3:0xf6
  v_bitop3_b32 v5, v5, v38, s84 bitop3:0xf6
  v_bitop3_b32 v5, v5, v39, s49 bitop3:0xf6
  v_bitop3_b32 v5, v5, v40, s84 bitop3:0xf6
  v_bitop3_b32 v5, v5, v41, s49 bitop3:0xf6
  v_bitop3_b32 v5, v5, v42, s84 bitop3:0xf6
  v_bitop3_b32 v5, v5, v43, s49 bitop3:0xf6
  v_bitop3_b32 v5, v5, v44, s84 bitop3:0xf6
  v_bitop3_b32 v5, v5, v45, s49 bitop3:0xf6
  v_bitop3_b32 v5, v5, v46, s84 bitop3:0xf6
  v_bitop3_b32 v5, v5, v47, s49 bitop3:0xf6
  v_cmp_ne_u32 vcc, 0, v5
  s_cmp_gt_u32 s90, 20000
  s_cbranch_scc1 L_epok
  s_cmp_lg_u64 vcc, 0
  s_cbranch_scc1 L_ep
L_epok:
  v_mov_b32 v5, s84
  v_mov_b32 v6, 0
  s_mov_b64 exec, 1
  buffer_store_dword v5, v6, s[24:27], 0 offen sc1
  s_mov_b64 exec, -1
L_fin:
L_end:
  s_endpgm
L_code_end:
.section .rodata,"a"
.p2align 6
.amdhsa_kernel standalone__seq2seq_rnn_t_joint__speech_kernel
  .amdhsa_next_free_vgpr 256
  .amdhsa_next_free_sgpr 102
  .amdhsa_accum_offset 256
  .amdhsa_group_segment_fixed_size 0
  .amdhsa_kernarg_size 80
  .amdhsa_user_sgpr_count 2
  .amdhsa_user_sgpr_kernarg_segment_ptr 1
  .amdhsa_system_sgpr_workgroup_id_x 1
.end_amdhsa_kernel
```
